```python
import torch

def _softmax(x, axis=-1):
    return torch.softmax(x, dim=axis)
def _gelu(x):
    return torch.nn.functional.gelu(x, approximate="tanh")
def _silu(x):
    return torch.nn.functional.silu(x)
def _sigmoid(x):
    return torch.sigmoid(x)
def _layernorm(x, axis=-1, eps=1e-5):
    m = x.mean(dim=axis, keepdim=True)
    v = x.var(dim=axis, keepdim=True, unbiased=False)
    return (x - m) / torch.sqrt(v + eps)
def _scatter_add(tgt, idx, src, axis=0):
    return tgt.clone().index_add_(axis, idx, src)
def _segment_sum(src, seg, n):
    out = torch.zeros((n,) + src.shape[1:], dtype=src.dtype)
    return out.index_add_(0, seg, src)
def _pad(x, pw):
    flat = tuple(v for pair in reversed(pw) for v in pair)
    return torch.nn.functional.pad(x, flat)

kernel_name = 'concat_heads__mha_block_cached__gqa_block_cached__near_ridge'

def setup_inputs():

    _w = (lambda a: (lambda t: t.to(torch.bfloat16) if t.is_floating_point() else t)(torch.as_tensor(a)))
    def _A_setup():
        B, Sq, D = 16, 96, 512
        H, Sk, Dh = 32, 512, 128
        return {
            "x": _w((lambda *s: torch.randn(*s, dtype=torch.bfloat16) * 0.8)(B, Sq, D)),
            "k_cache": _w((lambda *s: torch.randn(*s, dtype=torch.bfloat16) * 0.8)(B, H, Sk, Dh)),
            "v_cache": _w((lambda *s: torch.randn(*s, dtype=torch.bfloat16) * 0.05)(B, H, Sk, Dh)),
            "wq": _w((lambda *s: torch.randn(*s, dtype=torch.bfloat16) * 0.8)(D, H * Dh) * (D ** -0.5)),
            "wo": _w((lambda *s: torch.randn(*s, dtype=torch.bfloat16) * 0.05)(H * Dh, D) * ((H * Dh) ** -0.5)),
        }
    _A_in = _A_setup()

    def _B_setup():
        B, Sq, D = 16, 96, 512
        Hq, Hkv, Sk, Dh = 32, 32, 512, 128
        assert Hq % Hkv == 0, (Hq, Hkv)
        return {
            "x": _w((lambda *s: torch.randn(*s, dtype=torch.bfloat16) * 0.8)(B, Sq, D)),
            "k_cache": _w((lambda *s: torch.randn(*s, dtype=torch.bfloat16) * 0.8)(B, Hkv, Sk, Dh)),
            "v_cache": _w((lambda *s: torch.randn(*s, dtype=torch.bfloat16) * 0.05)(B, Hkv, Sk, Dh)),
            "wq": _w((lambda *s: torch.randn(*s, dtype=torch.bfloat16) * 0.8)(D, Hq * Dh) * (D ** -0.5)),
            "wo": _w((lambda *s: torch.randn(*s, dtype=torch.bfloat16) * 0.05)(Hq * Dh, D) * ((Hq * Dh) ** -0.5)),
        }
    _B_in = _B_setup()

    return {
        "A_x": _A_in["x"],
        "A_k_cache": _A_in["k_cache"],
        "A_v_cache": _A_in["v_cache"],
        "A_wq": _A_in["wq"],
        "A_wo": _A_in["wo"],
        "B_x": _B_in["x"],
        "B_k_cache": _B_in["k_cache"],
        "B_v_cache": _B_in["v_cache"],
        "B_wq": _B_in["wq"],
        "B_wo": _B_in["wo"],
    }

def reference(A_x, A_k_cache, A_v_cache, A_wq, A_wo, B_x, B_k_cache, B_v_cache, B_wq, B_wo):
    def _A_ref(x, k_cache, v_cache, wq, wo):
        B, Sq, D = x.shape
        H, Dh = 32, 128
        q = (lambda x, *d: x.permute(*d))((x @ wq).reshape(B, Sq, H, Dh), 0, 2, 1, 3)
        scores = torch.einsum("bhqd,bhkd->bhqk", q, k_cache) * (Dh ** -0.5)
        p = _softmax(scores, axis=-1)
        o = torch.einsum("bhqk,bhkd->bhqd", p, v_cache)
        return (lambda x, *d: x.permute(*d))(o, 0, 2, 1, 3).reshape(B, Sq, H * Dh) @ wo

    def _B_ref(x, k_cache, v_cache, wq, wo):
        B, Sq, D = x.shape
        Hq, Dh = 32, 128
        Hkv = k_cache.shape[1]
        rep = Hq // Hkv
        q = (lambda x, *d: x.permute(*d))((x @ wq).reshape(B, Sq, Hq, Dh), 0, 2, 1, 3)
        k = (lambda x, n, axis: torch.repeat_interleave(x, n, dim=axis))(k_cache, rep, axis=1)
        v = (lambda x, n, axis: torch.repeat_interleave(x, n, dim=axis))(v_cache, rep, axis=1)
        scores = torch.einsum("bhqd,bhkd->bhqk", q, k) * (Dh ** -0.5)
        p = _softmax(scores, axis=-1)
        o = torch.einsum("bhqk,bhkd->bhqd", p, v)
        return (lambda x, *d: x.permute(*d))(o, 0, 2, 1, 3).reshape(B, Sq, Hq * Dh) @ wo

    a = _A_ref(A_x, A_k_cache, A_v_cache, A_wq, A_wo)
    b = _B_ref(B_x, B_k_cache, B_v_cache, B_wq, B_wo)
    return torch.concatenate([a, b], axis=-1)
```

```asm
; @launch grid=(256,1,1) block=(512,1,1) lds=163840
.amdgcn_target "amdgcn-amd-amdhsa--gfx950"
.text
.globl concat_heads__mha_block_cached__gqa_block_cached__near_ridge_kernel
.p2align 8
.type concat_heads__mha_block_cached__gqa_block_cached__near_ridge_kernel,@function
concat_heads__mha_block_cached__gqa_block_cached__near_ridge_kernel:
    s_cmp_ge_u32 s2, 256
    s_cbranch_scc1 L_end
    s_getpc_b64 s[84:85]
L_cpf_here:
    v_lshrrev_b32 v1, 6, v0
    s_lshr_b32 s86, s2, 3
    s_lshl_b32 s86, s86, 13
    v_lshlrev_b32 v2, 4, v0
    v_add_u32 v2, s86, v2
    v_and_b32 v2, 0xffff, v2
    s_sub_u32 s84, s84, L_cpf_here-concat_heads__mha_block_cached__gqa_block_cached__near_ridge_kernel
    s_subb_u32 s85, s85, 0
    v_min_u32 v2, L_end-concat_heads__mha_block_cached__gqa_block_cached__near_ridge_kernel-16, v2
    v_and_b32 v2, -16, v2
    global_load_dwordx4 v[240:243], v2, s[84:85]
    s_load_dwordx16 s[4:19], s[0:1], 0
    s_load_dwordx8 s[20:27], s[0:1], 64
    s_load_dwordx2 s[28:29], s[0:1], 96
    v_lshrrev_b32 v1, 6, v0
    v_and_b32 v0, 63, v0
    s_and_b32 s35, s2, 7
    v_readfirstlane_b32 s30, v1
    s_lshr_b32 s33, s2, 3
    s_and_b32 s31, s35, 1
    s_and_b32 s32, s35, 6
    s_and_b32 s34, s33, 1
    s_add_u32 s32, s32, s34
    s_lshr_b32 s33, s33, 1
    s_lshl_b32 s34, s31, 4
    s_add_u32 s34, s34, s33
    s_lshl_b32 s34, s34, 3
    s_add_u32 s34, s34, s32
    s_waitcnt lgkmcnt(0)
    s_cmp_eq_u32 s31, 0
    s_cselect_b32 s60, s4, s14
    s_cselect_b32 s61, s5, s15
    s_cselect_b32 s62, s6, s16
    s_cselect_b32 s63, s7, s17
    s_cselect_b32 s64, s8, s18
    s_cselect_b32 s65, s9, s19
    s_cselect_b32 s66, s10, s20
    s_cselect_b32 s67, s11, s21
    s_cselect_b32 s68, s12, s22
    s_cselect_b32 s69, s13, s23
    s_memrealtime s[98:99]
    s_waitcnt lgkmcnt(0)
    s_mov_b32 s44, s66
    s_and_b32 s45, s67, 0xffff
    s_mov_b32 s46, 4194304
    s_mov_b32 s47, 0x20000
    s_mov_b32 s48, s60
    s_and_b32 s49, s61, 0xffff
    s_mov_b32 s50, 1572864
    s_mov_b32 s51, 0x20000
    v_lshrrev_b32 v3, 4, v0
    v_and_b32 v4, 15, v0
    v_lshlrev_b32 v5, 2, v3
    v_xor_b32 v5, v5, v4
    v_lshlrev_b32 v5, 4, v5
    v_lshl_add_u32 v16, v3, 13, v5
    s_lshr_b32 s76, s30, 2
    s_and_b32 s77, s30, 3
    s_lshl_b32 s70, s32, 10
    s_lshl_b32 s74, s76, 8
    s_add_u32 s70, s70, s74
    s_lshl_b32 s74, s77, 16
    s_add_u32 s70, s70, s74
    s_lshl_b32 s71, s76, 13
    s_lshl_b32 s74, s77, 11
    s_add_u32 s71, s71, s74
    v_lshrrev_b32 v6, 3, v0
    v_and_b32 v7, 7, v0
    v_lshrrev_b32 v8, 1, v6
    v_xor_b32 v9, v8, v7
    v_lshlrev_b32 v9, 4, v9
    v_lshl_add_u32 v17, v6, 10, v9
    v_add_u32 v8, 4, v8
    v_xor_b32 v9, v8, v7
    v_lshlrev_b32 v9, 4, v9
    v_lshl_add_u32 v18, v6, 10, v9
    s_lshl_b32 s76, s30, 1
    s_min_u32 s76, s76, 10
    s_lshl_b32 s73, s76, 10
    s_lshl_b32 s72, s76, 13
    s_mul_i32 s74, s33, 98304
    s_add_u32 s72, s72, s74
    s_and_b32 s80, s33, 7
    s_lshl_b32 s79, s80, 19
    s_lshl_b32 s80, s80, 7
    s_add_u32 m0, s73, 122880
    s_add_u32 s74, s80, 0
    s_and_b32 s74, s74, 1023
    s_add_u32 s74, s74, s72
    buffer_load_dwordx4 v17, s[48:51], s74 offen lds
    s_add_u32 m0, s73, 123904
    s_add_u32 s74, s80, 0
    s_and_b32 s74, s74, 1023
    s_add_u32 s74, s74, s72
    s_add_u32 s74, s74, 8192
    buffer_load_dwordx4 v18, s[48:51], s74 offen lds
    s_add_u32 m0, s71, 57344
    s_add_u32 s74, s79, 0
    s_and_b32 s74, s74, 4194303
    s_add_u32 s74, s74, s70
    buffer_load_dwordx4 v16, s[44:47], s74 offen lds
    s_add_u32 m0, s71, 58368
    s_add_u32 s74, s79, 0
    s_and_b32 s74, s74, 4194303
    s_add_u32 s74, s74, s70
    s_add_u32 s74, s74, 32768
    buffer_load_dwordx4 v16, s[44:47], s74 offen lds
    s_add_u32 m0, s71, 73728
    s_add_u32 s74, s79, 262144
    s_and_b32 s74, s74, 4194303
    s_add_u32 s74, s74, s70
    buffer_load_dwordx4 v16, s[44:47], s74 offen lds
    s_add_u32 m0, s71, 74752
    s_add_u32 s74, s79, 262144
    s_and_b32 s74, s74, 4194303
    s_add_u32 s74, s74, s70
    s_add_u32 s74, s74, 32768
    buffer_load_dwordx4 v16, s[44:47], s74 offen lds
    s_add_u32 m0, s73, 135168
    s_add_u32 s74, s80, 128
    s_and_b32 s74, s74, 1023
    s_add_u32 s74, s74, s72
    buffer_load_dwordx4 v17, s[48:51], s74 offen lds
    s_add_u32 m0, s73, 136192
    s_add_u32 s74, s80, 128
    s_and_b32 s74, s74, 1023
    s_add_u32 s74, s74, s72
    s_add_u32 s74, s74, 8192
    buffer_load_dwordx4 v18, s[48:51], s74 offen lds
    s_add_u32 m0, s71, 90112
    s_add_u32 s74, s79, 524288
    s_and_b32 s74, s74, 4194303
    s_add_u32 s74, s74, s70
    buffer_load_dwordx4 v16, s[44:47], s74 offen lds
    s_add_u32 m0, s71, 91136
    s_add_u32 s74, s79, 524288
    s_and_b32 s74, s74, 4194303
    s_add_u32 s74, s74, s70
    s_add_u32 s74, s74, 32768
    buffer_load_dwordx4 v16, s[44:47], s74 offen lds
    s_add_u32 m0, s71, 106496
    s_add_u32 s74, s79, 786432
    s_and_b32 s74, s74, 4194303
    s_add_u32 s74, s74, s70
    buffer_load_dwordx4 v16, s[44:47], s74 offen lds
    s_add_u32 m0, s71, 107520
    s_add_u32 s74, s79, 786432
    s_and_b32 s74, s74, 4194303
    s_add_u32 s74, s74, s70
    s_add_u32 s74, s74, 32768
    buffer_load_dwordx4 v16, s[44:47], s74 offen lds
    s_add_u32 m0, s73, 147456
    s_add_u32 s74, s80, 256
    s_and_b32 s74, s74, 1023
    s_add_u32 s74, s74, s72
    buffer_load_dwordx4 v17, s[48:51], s74 offen lds
    s_add_u32 m0, s73, 148480
    s_add_u32 s74, s80, 256
    s_and_b32 s74, s74, 1023
    s_add_u32 s74, s74, s72
    s_add_u32 s74, s74, 8192
    buffer_load_dwordx4 v18, s[48:51], s74 offen lds
    s_mov_b32 s36, s62
    s_and_b32 s37, s63, 0xffff
    s_mov_b32 s38, 67108864
    s_mov_b32 s39, 0x20000
    s_mov_b32 s40, s64
    s_and_b32 s41, s65, 0xffff
    s_mov_b32 s42, 67108864
    s_mov_b32 s43, 0x20000
    s_mov_b32 s56, s28
    s_and_b32 s57, s29, 0xffff
    s_mov_b32 s58, 288358400
    s_mov_b32 s59, 0x20000
    s_mov_b32 s52, s68
    s_and_b32 s53, s69, 0xffff
    s_mov_b32 s54, 4194304
    s_mov_b32 s55, 0x20000
    v_mov_b32 v200, 0
    v_mov_b32 v201, 0
    v_add_u32 v6, 0, v3
    v_xor_b32 v6, v6, v4
    v_lshlrev_b32 v6, 4, v6
    v_lshl_add_u32 v19, v3, 8, v6
    v_add_u32 v6, 4, v3
    v_xor_b32 v6, v6, v4
    v_lshlrev_b32 v6, 4, v6
    v_lshl_add_u32 v20, v3, 8, v6
    v_add_u32 v6, 8, v3
    v_xor_b32 v6, v6, v4
    v_lshlrev_b32 v6, 4, v6
    v_lshl_add_u32 v21, v3, 8, v6
    v_add_u32 v6, 12, v3
    v_xor_b32 v6, v6, v4
    v_lshlrev_b32 v6, 4, v6
    v_lshl_add_u32 v22, v3, 8, v6
    v_lshl_add_u32 v23, v3, 8, v5
    v_lshrrev_b32 v6, 5, v0
    v_and_b32 v7, 31, v0
    v_bfe_u32 v8, v0, 4, 1
    v_bfe_u32 v9, v0, 2, 2
    v_and_b32 v10, 3, v0
    v_lshlrev_b32 v11, 5, v8
    v_and_b32 v12, 1, v10
    v_lshl_add_u32 v11, v12, 4, v11
    v_lshrrev_b32 v12, 1, v10
    v_lshl_add_u32 v11, v12, 3, v11
    v_lshl_add_u32 v12, v6, 3, v9
    v_lshl_add_u32 v12, v12, 8, v11
    s_lshr_b32 s76, s30, 2
    s_lshl_b32 s76, s76, 13
    s_add_u32 s76, s76, 57344
    v_add_u32 v12, s76, v12
    s_and_b32 s77, s30, 3
    v_xor_b32 v13, s77, v9
    v_lshl_add_u32 v24, v13, 6, v12
    v_add_u32 v14, 32768, v24
    v_bfe_u32 v12, v7, 1, 3
    v_xor_b32 v12, v12, v6
    v_lshlrev_b32 v12, 4, v12
    v_lshl_add_u32 v12, v7, 7, v12
    v_xor_b32 v13, 0, v12
    v_add_u32 v26, 122880, v13
    v_xor_b32 v13, 32, v12
    v_add_u32 v27, 122880, v13
    v_xor_b32 v13, 64, v12
    v_add_u32 v28, 122880, v13
    v_xor_b32 v13, 96, v12
    v_add_u32 v29, 122880, v13
    v_lshlrev_b32 v12, 4, v0
    s_and_b32 s77, s30, 3
    s_lshl_b32 s77, s77, 11
    s_lshr_b32 s76, s30, 2
    s_mul_i32 s76, s76, 24576
    s_add_u32 s76, s76, s77
    s_add_u32 s76, s76, 65536
    v_add_u32 v30, s76, v12
    v_mov_b32 v236, 0
    s_cmp_eq_u32 s30, 3
    s_cbranch_scc1 L_ld_setup
    s_cmp_gt_u32 s30, 3
    s_cbranch_scc1 L_w_setup
L_att_setup:
    v_lshrrev_b32 v220, 5, v0
    v_and_b32 v221, 31, v0
    v_bfe_u32 v222, v0, 4, 1
    v_bfe_u32 v223, v0, 2, 2
    v_and_b32 v224, 3, v0
    v_and_b32 v225, 15, v221
    v_xor_b32 v225, v225, v220
    v_lshlrev_b32 v225, 4, v225
    v_lshl_add_u32 v225, v221, 8, v225
    v_xor_b32 v228, 0, v225
    v_xor_b32 v229, 32, v225
    v_xor_b32 v230, 64, v225
    v_xor_b32 v231, 96, v225
    v_xor_b32 v232, 128, v225
    v_xor_b32 v233, 160, v225
    v_xor_b32 v234, 192, v225
    v_xor_b32 v235, 224, v225
    v_lshl_add_u32 v225, v220, 2, v223
    v_lshlrev_b32 v225, 8, v225
    v_lshl_add_u32 v225, v222, 5, v225
    v_lshl_add_u32 v225, v224, 3, v225
    v_add_u32 v225, 32768, v225
    v_xor_b32 v226, 0, v223
    v_lshl_add_u32 v236, v226, 6, v225
    v_xor_b32 v226, 1, v223
    v_lshl_add_u32 v237, v226, 6, v225
    v_xor_b32 v226, 2, v223
    v_lshl_add_u32 v238, v226, 6, v225
    v_xor_b32 v226, 3, v223
    v_lshl_add_u32 v239, v226, 6, v225
    s_lshl_b32 s77, s30, 13
    v_lshlrev_b32 v225, 4, v0
    s_add_u32 s76, s77, 65536
    v_add_u32 v246, s76, v225
    s_add_u32 s76, s77, 90112
    v_add_u32 v247, s76, v225
    s_branch L_pro
L_ld_setup:
    v_lshrrev_b32 v6, 3, v0
    v_and_b32 v7, 7, v0
    v_bfe_u32 v8, v6, 1, 1
    v_lshlrev_b32 v8, 2, v8
    v_xor_b32 v8, v8, v7
    v_lshlrev_b32 v8, 4, v8
    v_lshl_add_u32 v200, v6, 10, v8
    s_lshl_b32 s83, s33, 5
    s_lshl_b32 s101, s32, 2
    s_add_u32 s83, s83, s101
    s_lshl_b32 s83, s83, 17
    s_add_u32 s94, s83, 24576
    s_add_u32 s83, s83, 32768
    s_mov_b32 s95, 0
    s_mov_b32 s96, 57344
    s_lshl_b32 s98, s32, 19
    s_mov_b32 s81, 1024
    s_branch L_pro
L_w_setup:
    s_sub_u32 s78, s30, 4
    s_lshl_b32 s84, s78, 11
    v_lshrrev_b32 v200, 5, v0
    v_bfe_u32 v202, v0, 4, 1
    v_bfe_u32 v203, v0, 2, 2
    v_and_b32 v204, 3, v0
    v_lshlrev_b32 v205, 5, v202
    v_and_b32 v206, 1, v204
    v_lshl_add_u32 v205, v206, 4, v205
    v_lshrrev_b32 v206, 1, v204
    v_lshl_add_u32 v205, v206, 3, v205
    v_lshl_add_u32 v206, v200, 2, v203
    v_lshl_add_u32 v206, v206, 7, v205
    v_add_u32 v206, s84, v206
    v_lshrrev_b32 v207, 1, v203
    v_xor_b32 v208, 0, v207
    v_lshl_add_u32 v220, v208, 6, v206
    v_add_u32 v222, 65536, v220
    v_add_u32 v224, 131072, v220
    v_xor_b32 v208, 1, v207
    v_lshl_add_u32 v221, v208, 6, v206
    v_add_u32 v223, 65536, v221
    v_add_u32 v225, 131072, v221
    v_lshl_add_u32 v206, v200, 3, v203
    v_lshl_add_u32 v206, v206, 8, v205
    v_xor_b32 v207, s78, v203
    v_lshl_add_u32 v206, v207, 6, v206
    v_add_u32 v228, 114688, v206
    v_and_b32 v206, 31, v0
    v_bfe_u32 v207, v206, 1, 3
    v_xor_b32 v207, v207, v200
    v_lshlrev_b32 v207, 4, v207
    v_lshl_add_u32 v207, v206, 7, v207
    v_add_u32 v229, 65536, v207
    v_xor_b32 v208, 32, v207
    v_add_u32 v230, 65536, v208
    v_xor_b32 v208, 64, v207
    v_add_u32 v231, 65536, v208
    v_xor_b32 v208, 96, v207
    v_add_u32 v232, 65536, v208
    v_lshlrev_b32 v206, 4, v0
    s_lshl_b32 s84, s78, 11
    s_add_u32 s84, s84, 114688
    v_add_u32 v233, s84, v206
    v_add_u32 v226, 90112, v206
    v_add_u32 v227, 139264, v206
    s_mul_i32 s84, s34, 98304
    s_mul_i32 s85, s78, 24576
    s_add_u32 s84, s84, s85
    s_add_u32 s84, s84, 50331648
    v_add_u32 v236, s84, v206
    s_branch L_pro
L_pro:
    s_waitcnt vmcnt(10)
    s_barrier
    ds_read_b64_tr_b16 v[128:129], v24 offset:0
    ds_read_b64_tr_b16 v[130:131], v24 offset:1024
    ds_read_b64_tr_b16 v[132:133], v24 offset:4096
    ds_read_b64_tr_b16 v[134:135], v24 offset:5120
    ds_read_b128 v[80:83], v26 offset:0
    ds_read_b128 v[84:87], v26 offset:4096
    ds_read_b128 v[88:91], v26 offset:8192
    ds_read_b128 v[92:95], v27 offset:0
    ds_read_b128 v[96:99], v27 offset:4096
    ds_read_b128 v[100:103], v27 offset:8192
    s_waitcnt lgkmcnt(0)
    s_waitcnt vmcnt(8)
    s_barrier
    v_mfma_f32_32x32x16_bf16 v[32:47], v[128:131], v[80:83], 0
    ds_read_b64_tr_b16 v[136:137], v24 offset:16384
    ds_read_b64_tr_b16 v[138:139], v24 offset:17408
    ds_read_b64_tr_b16 v[140:141], v24 offset:20480
    ds_read_b64_tr_b16 v[142:143], v24 offset:21504
    v_mfma_f32_32x32x16_bf16 v[48:63], v[128:131], v[84:87], 0
    ds_read_b128 v[104:107], v28 offset:0
    ds_read_b128 v[108:111], v28 offset:4096
    ds_read_b128 v[112:115], v28 offset:8192
    v_mfma_f32_32x32x16_bf16 v[64:79], v[128:131], v[88:91], 0
    ds_read_b128 v[116:119], v29 offset:0
    ds_read_b128 v[120:123], v29 offset:4096
    ds_read_b128 v[124:127], v29 offset:8192
    v_mfma_f32_32x32x16_bf16 v[32:47], v[132:135], v[92:95], v[32:47]
    s_add_u32 m0, s71, 57344
    s_add_u32 s74, s79, 1048576
    s_and_b32 s74, s74, 4194303
    s_add_u32 s74, s74, s70
    buffer_load_dwordx4 v16, s[44:47], s74 offen lds
    s_add_u32 m0, s71, 58368
    s_add_u32 s74, s79, 1048576
    s_and_b32 s74, s74, 4194303
    s_add_u32 s74, s74, s70
    s_add_u32 s74, s74, 32768
    buffer_load_dwordx4 v16, s[44:47], s74 offen lds
    v_mfma_f32_32x32x16_bf16 v[48:63], v[132:135], v[96:99], v[48:63]
    v_mfma_f32_32x32x16_bf16 v[64:79], v[132:135], v[100:103], v[64:79]
    s_waitcnt lgkmcnt(0)
    s_waitcnt vmcnt(6)
    s_barrier
    v_mfma_f32_32x32x16_bf16 v[32:47], v[136:139], v[104:107], v[32:47]
    ds_read_b64_tr_b16 v[128:129], v14 offset:0
    ds_read_b64_tr_b16 v[130:131], v14 offset:1024
    ds_read_b64_tr_b16 v[132:133], v14 offset:4096
    ds_read_b64_tr_b16 v[134:135], v14 offset:5120
    v_mfma_f32_32x32x16_bf16 v[48:63], v[136:139], v[108:111], v[48:63]
    ds_read_b128 v[80:83], v26 offset:12288
    ds_read_b128 v[84:87], v26 offset:16384
    ds_read_b128 v[88:91], v26 offset:20480
    v_mfma_f32_32x32x16_bf16 v[64:79], v[136:139], v[112:115], v[64:79]
    ds_read_b128 v[92:95], v27 offset:12288
    ds_read_b128 v[96:99], v27 offset:16384
    ds_read_b128 v[100:103], v27 offset:20480
    v_mfma_f32_32x32x16_bf16 v[32:47], v[140:143], v[116:119], v[32:47]
    s_add_u32 m0, s71, 73728
    s_add_u32 s74, s79, 1310720
    s_and_b32 s74, s74, 4194303
    s_add_u32 s74, s74, s70
    buffer_load_dwordx4 v16, s[44:47], s74 offen lds
    s_add_u32 m0, s71, 74752
    s_add_u32 s74, s79, 1310720
    s_and_b32 s74, s74, 4194303
    s_add_u32 s74, s74, s70
    s_add_u32 s74, s74, 32768
    buffer_load_dwordx4 v16, s[44:47], s74 offen lds
    v_mfma_f32_32x32x16_bf16 v[48:63], v[140:143], v[120:123], v[48:63]
    s_add_u32 m0, s73, 122880
    s_add_u32 s74, s80, 384
    s_and_b32 s74, s74, 1023
    s_add_u32 s74, s74, s72
    buffer_load_dwordx4 v17, s[48:51], s74 offen lds
    s_add_u32 m0, s73, 123904
    s_add_u32 s74, s80, 384
    s_and_b32 s74, s74, 1023
    s_add_u32 s74, s74, s72
    s_add_u32 s74, s74, 8192
    buffer_load_dwordx4 v18, s[48:51], s74 offen lds
    v_mfma_f32_32x32x16_bf16 v[64:79], v[140:143], v[124:127], v[64:79]
    s_waitcnt lgkmcnt(0)
    s_waitcnt vmcnt(8)
    s_barrier
    v_mfma_f32_32x32x16_bf16 v[32:47], v[128:131], v[80:83], v[32:47]
    ds_read_b64_tr_b16 v[136:137], v14 offset:16384
    ds_read_b64_tr_b16 v[138:139], v14 offset:17408
    ds_read_b64_tr_b16 v[140:141], v14 offset:20480
    ds_read_b64_tr_b16 v[142:143], v14 offset:21504
    v_mfma_f32_32x32x16_bf16 v[48:63], v[128:131], v[84:87], v[48:63]
    ds_read_b128 v[104:107], v28 offset:12288
    ds_read_b128 v[108:111], v28 offset:16384
    ds_read_b128 v[112:115], v28 offset:20480
    v_mfma_f32_32x32x16_bf16 v[64:79], v[128:131], v[88:91], v[64:79]
    ds_read_b128 v[116:119], v29 offset:12288
    ds_read_b128 v[120:123], v29 offset:16384
    ds_read_b128 v[124:127], v29 offset:20480
    v_mfma_f32_32x32x16_bf16 v[32:47], v[132:135], v[92:95], v[32:47]
    s_add_u32 m0, s71, 90112
    s_add_u32 s74, s79, 1572864
    s_and_b32 s74, s74, 4194303
    s_add_u32 s74, s74, s70
    buffer_load_dwordx4 v16, s[44:47], s74 offen lds
    s_add_u32 m0, s71, 91136
    s_add_u32 s74, s79, 1572864
    s_and_b32 s74, s74, 4194303
    s_add_u32 s74, s74, s70
    s_add_u32 s74, s74, 32768
    buffer_load_dwordx4 v16, s[44:47], s74 offen lds
    v_mfma_f32_32x32x16_bf16 v[48:63], v[132:135], v[96:99], v[48:63]
    v_mfma_f32_32x32x16_bf16 v[64:79], v[132:135], v[100:103], v[64:79]
    s_waitcnt lgkmcnt(0)
    s_waitcnt vmcnt(6)
    s_barrier
    v_mfma_f32_32x32x16_bf16 v[32:47], v[136:139], v[104:107], v[32:47]
    ds_read_b64_tr_b16 v[128:129], v24 offset:0
    ds_read_b64_tr_b16 v[130:131], v24 offset:1024
    ds_read_b64_tr_b16 v[132:133], v24 offset:4096
    ds_read_b64_tr_b16 v[134:135], v24 offset:5120
    v_mfma_f32_32x32x16_bf16 v[48:63], v[136:139], v[108:111], v[48:63]
    ds_read_b128 v[80:83], v26 offset:24576
    ds_read_b128 v[84:87], v26 offset:28672
    ds_read_b128 v[88:91], v26 offset:32768
    v_mfma_f32_32x32x16_bf16 v[64:79], v[136:139], v[112:115], v[64:79]
    ds_read_b128 v[92:95], v27 offset:24576
    ds_read_b128 v[96:99], v27 offset:28672
    ds_read_b128 v[100:103], v27 offset:32768
    v_mfma_f32_32x32x16_bf16 v[32:47], v[140:143], v[116:119], v[32:47]
    s_add_u32 m0, s71, 106496
    s_add_u32 s74, s79, 1835008
    s_and_b32 s74, s74, 4194303
    s_add_u32 s74, s74, s70
    buffer_load_dwordx4 v16, s[44:47], s74 offen lds
    s_add_u32 m0, s71, 107520
    s_add_u32 s74, s79, 1835008
    s_and_b32 s74, s74, 4194303
    s_add_u32 s74, s74, s70
    s_add_u32 s74, s74, 32768
    buffer_load_dwordx4 v16, s[44:47], s74 offen lds
    v_mfma_f32_32x32x16_bf16 v[48:63], v[140:143], v[120:123], v[48:63]
    s_add_u32 m0, s73, 135168
    s_add_u32 s74, s80, 512
    s_and_b32 s74, s74, 1023
    s_add_u32 s74, s74, s72
    buffer_load_dwordx4 v17, s[48:51], s74 offen lds
    s_add_u32 m0, s73, 136192
    s_add_u32 s74, s80, 512
    s_and_b32 s74, s74, 1023
    s_add_u32 s74, s74, s72
    s_add_u32 s74, s74, 8192
    buffer_load_dwordx4 v18, s[48:51], s74 offen lds
    v_mfma_f32_32x32x16_bf16 v[64:79], v[140:143], v[124:127], v[64:79]
    s_waitcnt lgkmcnt(0)
    s_waitcnt vmcnt(8)
    s_barrier
    v_mfma_f32_32x32x16_bf16 v[32:47], v[128:131], v[80:83], v[32:47]
    ds_read_b64_tr_b16 v[136:137], v24 offset:16384
    ds_read_b64_tr_b16 v[138:139], v24 offset:17408
    ds_read_b64_tr_b16 v[140:141], v24 offset:20480
    ds_read_b64_tr_b16 v[142:143], v24 offset:21504
    v_mfma_f32_32x32x16_bf16 v[48:63], v[128:131], v[84:87], v[48:63]
    ds_read_b128 v[104:107], v28 offset:24576
    ds_read_b128 v[108:111], v28 offset:28672
    ds_read_b128 v[112:115], v28 offset:32768
    v_mfma_f32_32x32x16_bf16 v[64:79], v[128:131], v[88:91], v[64:79]
    ds_read_b128 v[116:119], v29 offset:24576
    ds_read_b128 v[120:123], v29 offset:28672
    ds_read_b128 v[124:127], v29 offset:32768
    v_mfma_f32_32x32x16_bf16 v[32:47], v[132:135], v[92:95], v[32:47]
    s_add_u32 m0, s71, 57344
    s_add_u32 s74, s79, 2097152
    s_and_b32 s74, s74, 4194303
    s_add_u32 s74, s74, s70
    buffer_load_dwordx4 v16, s[44:47], s74 offen lds
    s_add_u32 m0, s71, 58368
    s_add_u32 s74, s79, 2097152
    s_and_b32 s74, s74, 4194303
    s_add_u32 s74, s74, s70
    s_add_u32 s74, s74, 32768
    buffer_load_dwordx4 v16, s[44:47], s74 offen lds
    v_mfma_f32_32x32x16_bf16 v[48:63], v[132:135], v[96:99], v[48:63]
    v_mfma_f32_32x32x16_bf16 v[64:79], v[132:135], v[100:103], v[64:79]
    s_waitcnt lgkmcnt(0)
    s_waitcnt vmcnt(6)
    s_barrier
    v_mfma_f32_32x32x16_bf16 v[32:47], v[136:139], v[104:107], v[32:47]
    ds_read_b64_tr_b16 v[128:129], v14 offset:0
    ds_read_b64_tr_b16 v[130:131], v14 offset:1024
    ds_read_b64_tr_b16 v[132:133], v14 offset:4096
    ds_read_b64_tr_b16 v[134:135], v14 offset:5120
    v_mfma_f32_32x32x16_bf16 v[48:63], v[136:139], v[108:111], v[48:63]
    ds_read_b128 v[80:83], v26 offset:0
    ds_read_b128 v[84:87], v26 offset:4096
    ds_read_b128 v[88:91], v26 offset:8192
    v_mfma_f32_32x32x16_bf16 v[64:79], v[136:139], v[112:115], v[64:79]
    ds_read_b128 v[92:95], v27 offset:0
    ds_read_b128 v[96:99], v27 offset:4096
    ds_read_b128 v[100:103], v27 offset:8192
    v_mfma_f32_32x32x16_bf16 v[32:47], v[140:143], v[116:119], v[32:47]
    s_add_u32 m0, s71, 73728
    s_add_u32 s74, s79, 2359296
    s_and_b32 s74, s74, 4194303
    s_add_u32 s74, s74, s70
    buffer_load_dwordx4 v16, s[44:47], s74 offen lds
    s_add_u32 m0, s71, 74752
    s_add_u32 s74, s79, 2359296
    s_and_b32 s74, s74, 4194303
    s_add_u32 s74, s74, s70
    s_add_u32 s74, s74, 32768
    buffer_load_dwordx4 v16, s[44:47], s74 offen lds
    v_mfma_f32_32x32x16_bf16 v[48:63], v[140:143], v[120:123], v[48:63]
    s_add_u32 m0, s73, 147456
    s_add_u32 s74, s80, 640
    s_and_b32 s74, s74, 1023
    s_add_u32 s74, s74, s72
    buffer_load_dwordx4 v17, s[48:51], s74 offen lds
    s_add_u32 m0, s73, 148480
    s_add_u32 s74, s80, 640
    s_and_b32 s74, s74, 1023
    s_add_u32 s74, s74, s72
    s_add_u32 s74, s74, 8192
    buffer_load_dwordx4 v18, s[48:51], s74 offen lds
    v_mfma_f32_32x32x16_bf16 v[64:79], v[140:143], v[124:127], v[64:79]
    s_waitcnt lgkmcnt(0)
    s_waitcnt vmcnt(8)
    s_barrier
    v_mfma_f32_32x32x16_bf16 v[32:47], v[128:131], v[80:83], v[32:47]
    ds_read_b64_tr_b16 v[136:137], v14 offset:16384
    ds_read_b64_tr_b16 v[138:139], v14 offset:17408
    ds_read_b64_tr_b16 v[140:141], v14 offset:20480
    ds_read_b64_tr_b16 v[142:143], v14 offset:21504
    v_mfma_f32_32x32x16_bf16 v[48:63], v[128:131], v[84:87], v[48:63]
    ds_read_b128 v[104:107], v28 offset:0
    ds_read_b128 v[108:111], v28 offset:4096
    ds_read_b128 v[112:115], v28 offset:8192
    v_mfma_f32_32x32x16_bf16 v[64:79], v[128:131], v[88:91], v[64:79]
    ds_read_b128 v[116:119], v29 offset:0
    ds_read_b128 v[120:123], v29 offset:4096
    ds_read_b128 v[124:127], v29 offset:8192
    v_mfma_f32_32x32x16_bf16 v[32:47], v[132:135], v[92:95], v[32:47]
    s_add_u32 m0, s71, 90112
    s_add_u32 s74, s79, 2621440
    s_and_b32 s74, s74, 4194303
    s_add_u32 s74, s74, s70
    buffer_load_dwordx4 v16, s[44:47], s74 offen lds
    s_add_u32 m0, s71, 91136
    s_add_u32 s74, s79, 2621440
    s_and_b32 s74, s74, 4194303
    s_add_u32 s74, s74, s70
    s_add_u32 s74, s74, 32768
    buffer_load_dwordx4 v16, s[44:47], s74 offen lds
    v_mfma_f32_32x32x16_bf16 v[48:63], v[132:135], v[96:99], v[48:63]
    v_mfma_f32_32x32x16_bf16 v[64:79], v[132:135], v[100:103], v[64:79]
    s_waitcnt lgkmcnt(0)
    s_waitcnt vmcnt(6)
    s_barrier
    v_mfma_f32_32x32x16_bf16 v[32:47], v[136:139], v[104:107], v[32:47]
    ds_read_b64_tr_b16 v[128:129], v24 offset:0
    ds_read_b64_tr_b16 v[130:131], v24 offset:1024
    ds_read_b64_tr_b16 v[132:133], v24 offset:4096
    ds_read_b64_tr_b16 v[134:135], v24 offset:5120
    v_mfma_f32_32x32x16_bf16 v[48:63], v[136:139], v[108:111], v[48:63]
    ds_read_b128 v[80:83], v26 offset:12288
    ds_read_b128 v[84:87], v26 offset:16384
    ds_read_b128 v[88:91], v26 offset:20480
    v_mfma_f32_32x32x16_bf16 v[64:79], v[136:139], v[112:115], v[64:79]
    ds_read_b128 v[92:95], v27 offset:12288
    ds_read_b128 v[96:99], v27 offset:16384
    ds_read_b128 v[100:103], v27 offset:20480
    v_mfma_f32_32x32x16_bf16 v[32:47], v[140:143], v[116:119], v[32:47]
    s_add_u32 m0, s71, 106496
    s_add_u32 s74, s79, 2883584
    s_and_b32 s74, s74, 4194303
    s_add_u32 s74, s74, s70
    buffer_load_dwordx4 v16, s[44:47], s74 offen lds
    s_add_u32 m0, s71, 107520
    s_add_u32 s74, s79, 2883584
    s_and_b32 s74, s74, 4194303
    s_add_u32 s74, s74, s70
    s_add_u32 s74, s74, 32768
    buffer_load_dwordx4 v16, s[44:47], s74 offen lds
    v_mfma_f32_32x32x16_bf16 v[48:63], v[140:143], v[120:123], v[48:63]
    s_add_u32 m0, s73, 122880
    s_add_u32 s74, s80, 768
    s_and_b32 s74, s74, 1023
    s_add_u32 s74, s74, s72
    buffer_load_dwordx4 v17, s[48:51], s74 offen lds
    s_add_u32 m0, s73, 123904
    s_add_u32 s74, s80, 768
    s_and_b32 s74, s74, 1023
    s_add_u32 s74, s74, s72
    s_add_u32 s74, s74, 8192
    buffer_load_dwordx4 v18, s[48:51], s74 offen lds
    v_mfma_f32_32x32x16_bf16 v[64:79], v[140:143], v[124:127], v[64:79]
    s_waitcnt lgkmcnt(0)
    s_waitcnt vmcnt(8)
    s_barrier
    v_mfma_f32_32x32x16_bf16 v[32:47], v[128:131], v[80:83], v[32:47]
    ds_read_b64_tr_b16 v[136:137], v24 offset:16384
    ds_read_b64_tr_b16 v[138:139], v24 offset:17408
    ds_read_b64_tr_b16 v[140:141], v24 offset:20480
    ds_read_b64_tr_b16 v[142:143], v24 offset:21504
    v_mfma_f32_32x32x16_bf16 v[48:63], v[128:131], v[84:87], v[48:63]
    ds_read_b128 v[104:107], v28 offset:12288
    ds_read_b128 v[108:111], v28 offset:16384
    ds_read_b128 v[112:115], v28 offset:20480
    v_mfma_f32_32x32x16_bf16 v[64:79], v[128:131], v[88:91], v[64:79]
    ds_read_b128 v[116:119], v29 offset:12288
    ds_read_b128 v[120:123], v29 offset:16384
    ds_read_b128 v[124:127], v29 offset:20480
    v_mfma_f32_32x32x16_bf16 v[32:47], v[132:135], v[92:95], v[32:47]
    s_add_u32 m0, s71, 57344
    s_add_u32 s74, s79, 3145728
    s_and_b32 s74, s74, 4194303
    s_add_u32 s74, s74, s70
    buffer_load_dwordx4 v16, s[44:47], s74 offen lds
    s_add_u32 m0, s71, 58368
    s_add_u32 s74, s79, 3145728
    s_and_b32 s74, s74, 4194303
    s_add_u32 s74, s74, s70
    s_add_u32 s74, s74, 32768
    buffer_load_dwordx4 v16, s[44:47], s74 offen lds
    v_mfma_f32_32x32x16_bf16 v[48:63], v[132:135], v[96:99], v[48:63]
    v_mfma_f32_32x32x16_bf16 v[64:79], v[132:135], v[100:103], v[64:79]
    s_waitcnt lgkmcnt(0)
    s_waitcnt vmcnt(6)
    s_barrier
    v_mfma_f32_32x32x16_bf16 v[32:47], v[136:139], v[104:107], v[32:47]
    ds_read_b64_tr_b16 v[128:129], v14 offset:0
    ds_read_b64_tr_b16 v[130:131], v14 offset:1024
    ds_read_b64_tr_b16 v[132:133], v14 offset:4096
    ds_read_b64_tr_b16 v[134:135], v14 offset:5120
    v_mfma_f32_32x32x16_bf16 v[48:63], v[136:139], v[108:111], v[48:63]
    ds_read_b128 v[80:83], v26 offset:24576
    ds_read_b128 v[84:87], v26 offset:28672
    ds_read_b128 v[88:91], v26 offset:32768
    v_mfma_f32_32x32x16_bf16 v[64:79], v[136:139], v[112:115], v[64:79]
    ds_read_b128 v[92:95], v27 offset:24576
    ds_read_b128 v[96:99], v27 offset:28672
    ds_read_b128 v[100:103], v27 offset:32768
    v_mfma_f32_32x32x16_bf16 v[32:47], v[140:143], v[116:119], v[32:47]
    s_add_u32 m0, s71, 73728
    s_add_u32 s74, s79, 3407872
    s_and_b32 s74, s74, 4194303
    s_add_u32 s74, s74, s70
    buffer_load_dwordx4 v16, s[44:47], s74 offen lds
    s_add_u32 m0, s71, 74752
    s_add_u32 s74, s79, 3407872
    s_and_b32 s74, s74, 4194303
    s_add_u32 s74, s74, s70
    s_add_u32 s74, s74, 32768
    buffer_load_dwordx4 v16, s[44:47], s74 offen lds
    v_mfma_f32_32x32x16_bf16 v[48:63], v[140:143], v[120:123], v[48:63]
    s_add_u32 m0, s73, 135168
    s_add_u32 s74, s80, 896
    s_and_b32 s74, s74, 1023
    s_add_u32 s74, s74, s72
    buffer_load_dwordx4 v17, s[48:51], s74 offen lds
    s_add_u32 m0, s73, 136192
    s_add_u32 s74, s80, 896
    s_and_b32 s74, s74, 1023
    s_add_u32 s74, s74, s72
    s_add_u32 s74, s74, 8192
    buffer_load_dwordx4 v18, s[48:51], s74 offen lds
    v_mfma_f32_32x32x16_bf16 v[64:79], v[140:143], v[124:127], v[64:79]
    s_waitcnt lgkmcnt(0)
    s_waitcnt vmcnt(8)
    s_barrier
    v_mfma_f32_32x32x16_bf16 v[32:47], v[128:131], v[80:83], v[32:47]
    ds_read_b64_tr_b16 v[136:137], v14 offset:16384
    ds_read_b64_tr_b16 v[138:139], v14 offset:17408
    ds_read_b64_tr_b16 v[140:141], v14 offset:20480
    ds_read_b64_tr_b16 v[142:143], v14 offset:21504
    v_mfma_f32_32x32x16_bf16 v[48:63], v[128:131], v[84:87], v[48:63]
    ds_read_b128 v[104:107], v28 offset:24576
    ds_read_b128 v[108:111], v28 offset:28672
    ds_read_b128 v[112:115], v28 offset:32768
    v_mfma_f32_32x32x16_bf16 v[64:79], v[128:131], v[88:91], v[64:79]
    ds_read_b128 v[116:119], v29 offset:24576
    ds_read_b128 v[120:123], v29 offset:28672
    ds_read_b128 v[124:127], v29 offset:32768
    v_mfma_f32_32x32x16_bf16 v[32:47], v[132:135], v[92:95], v[32:47]
    s_add_u32 m0, s71, 90112
    s_add_u32 s74, s79, 3670016
    s_and_b32 s74, s74, 4194303
    s_add_u32 s74, s74, s70
    buffer_load_dwordx4 v16, s[44:47], s74 offen lds
    s_add_u32 m0, s71, 91136
    s_add_u32 s74, s79, 3670016
    s_and_b32 s74, s74, 4194303
    s_add_u32 s74, s74, s70
    s_add_u32 s74, s74, 32768
    buffer_load_dwordx4 v16, s[44:47], s74 offen lds
    v_mfma_f32_32x32x16_bf16 v[48:63], v[132:135], v[96:99], v[48:63]
    v_mfma_f32_32x32x16_bf16 v[64:79], v[132:135], v[100:103], v[64:79]
    s_waitcnt lgkmcnt(0)
    s_waitcnt vmcnt(6)
    s_barrier
    v_mfma_f32_32x32x16_bf16 v[32:47], v[136:139], v[104:107], v[32:47]
    ds_read_b64_tr_b16 v[128:129], v24 offset:0
    ds_read_b64_tr_b16 v[130:131], v24 offset:1024
    ds_read_b64_tr_b16 v[132:133], v24 offset:4096
    ds_read_b64_tr_b16 v[134:135], v24 offset:5120
    v_mfma_f32_32x32x16_bf16 v[48:63], v[136:139], v[108:111], v[48:63]
    ds_read_b128 v[80:83], v26 offset:0
    ds_read_b128 v[84:87], v26 offset:4096
    ds_read_b128 v[88:91], v26 offset:8192
    v_mfma_f32_32x32x16_bf16 v[64:79], v[136:139], v[112:115], v[64:79]
    ds_read_b128 v[92:95], v27 offset:0
    ds_read_b128 v[96:99], v27 offset:4096
    ds_read_b128 v[100:103], v27 offset:8192
    v_mfma_f32_32x32x16_bf16 v[32:47], v[140:143], v[116:119], v[32:47]
    s_add_u32 m0, s71, 106496
    s_add_u32 s74, s79, 3932160
    s_and_b32 s74, s74, 4194303
    s_add_u32 s74, s74, s70
    buffer_load_dwordx4 v16, s[44:47], s74 offen lds
    s_add_u32 m0, s71, 107520
    s_add_u32 s74, s79, 3932160
    s_and_b32 s74, s74, 4194303
    s_add_u32 s74, s74, s70
    s_add_u32 s74, s74, 32768
    buffer_load_dwordx4 v16, s[44:47], s74 offen lds
    v_mfma_f32_32x32x16_bf16 v[48:63], v[140:143], v[120:123], v[48:63]
    v_mfma_f32_32x32x16_bf16 v[64:79], v[140:143], v[124:127], v[64:79]
    s_lshl_b32 s86, s33, 5
    s_lshl_b32 s87, s32, 2
    s_add_u32 s86, s86, s87
    s_lshl_b32 s85, s86, 17
    s_lshl_b32 s87, s30, 12
    s_add_u32 m0, s87, 0
    s_add_u32 s88, s85, s87
    buffer_load_dwordx4 v19, s[36:39], s88 offen offset:0 nt lds
    buffer_load_dwordx4 v20, s[36:39], s88 offen offset:1024 nt lds
    buffer_load_dwordx4 v21, s[36:39], s88 offen offset:2048 nt lds
    buffer_load_dwordx4 v22, s[36:39], s88 offen offset:3072 nt lds
    s_waitcnt lgkmcnt(0)
    s_waitcnt vmcnt(10)
    s_barrier
    v_mfma_f32_32x32x16_bf16 v[32:47], v[128:131], v[80:83], v[32:47]
    ds_read_b64_tr_b16 v[136:137], v24 offset:16384
    ds_read_b64_tr_b16 v[138:139], v24 offset:17408
    ds_read_b64_tr_b16 v[140:141], v24 offset:20480
    ds_read_b64_tr_b16 v[142:143], v24 offset:21504
    v_mfma_f32_32x32x16_bf16 v[48:63], v[128:131], v[84:87], v[48:63]
    ds_read_b128 v[104:107], v28 offset:0
    ds_read_b128 v[108:111], v28 offset:4096
    ds_read_b128 v[112:115], v28 offset:8192
    v_mfma_f32_32x32x16_bf16 v[64:79], v[128:131], v[88:91], v[64:79]
    ds_read_b128 v[116:119], v29 offset:0
    ds_read_b128 v[120:123], v29 offset:4096
    ds_read_b128 v[124:127], v29 offset:8192
    v_mfma_f32_32x32x16_bf16 v[32:47], v[132:135], v[92:95], v[32:47]
    v_mfma_f32_32x32x16_bf16 v[48:63], v[132:135], v[96:99], v[48:63]
    v_mfma_f32_32x32x16_bf16 v[64:79], v[132:135], v[100:103], v[64:79]
    s_mul_i32 s87, s30, 3072
    s_add_u32 m0, s87, 32768
    s_add_u32 s88, s85, s87
    buffer_load_dwordx4 v23, s[40:43], s88 offen offset:0 nt lds
    buffer_load_dwordx4 v23, s[40:43], s88 offen offset:1024 nt lds
    buffer_load_dwordx4 v23, s[40:43], s88 offen offset:2048 nt lds
    s_waitcnt lgkmcnt(0)
    s_waitcnt vmcnt(9)
    s_barrier
    v_mfma_f32_32x32x16_bf16 v[32:47], v[136:139], v[104:107], v[32:47]
    ds_read_b64_tr_b16 v[128:129], v14 offset:0
    ds_read_b64_tr_b16 v[130:131], v14 offset:1024
    ds_read_b64_tr_b16 v[132:133], v14 offset:4096
    ds_read_b64_tr_b16 v[134:135], v14 offset:5120
    v_mfma_f32_32x32x16_bf16 v[48:63], v[136:139], v[108:111], v[48:63]
    ds_read_b128 v[80:83], v26 offset:12288
    ds_read_b128 v[84:87], v26 offset:16384
    ds_read_b128 v[88:91], v26 offset:20480
    v_mfma_f32_32x32x16_bf16 v[64:79], v[136:139], v[112:115], v[64:79]
    ds_read_b128 v[92:95], v27 offset:12288
    ds_read_b128 v[96:99], v27 offset:16384
    ds_read_b128 v[100:103], v27 offset:20480
    v_mfma_f32_32x32x16_bf16 v[32:47], v[140:143], v[116:119], v[32:47]
    v_mfma_f32_32x32x16_bf16 v[48:63], v[140:143], v[120:123], v[48:63]
    v_mfma_f32_32x32x16_bf16 v[64:79], v[140:143], v[124:127], v[64:79]
    s_waitcnt lgkmcnt(0)
    s_waitcnt vmcnt(7)
    s_barrier
    v_mfma_f32_32x32x16_bf16 v[32:47], v[128:131], v[80:83], v[32:47]
    ds_read_b64_tr_b16 v[136:137], v14 offset:16384
    ds_read_b64_tr_b16 v[138:139], v14 offset:17408
    ds_read_b64_tr_b16 v[140:141], v14 offset:20480
    ds_read_b64_tr_b16 v[142:143], v14 offset:21504
    v_mfma_f32_32x32x16_bf16 v[48:63], v[128:131], v[84:87], v[48:63]
    ds_read_b128 v[104:107], v28 offset:12288
    ds_read_b128 v[108:111], v28 offset:16384
    ds_read_b128 v[112:115], v28 offset:20480
    v_mfma_f32_32x32x16_bf16 v[64:79], v[128:131], v[88:91], v[64:79]
    ds_read_b128 v[116:119], v29 offset:12288
    ds_read_b128 v[120:123], v29 offset:16384
    ds_read_b128 v[124:127], v29 offset:20480
    v_mfma_f32_32x32x16_bf16 v[32:47], v[132:135], v[92:95], v[32:47]
    v_mfma_f32_32x32x16_bf16 v[48:63], v[132:135], v[96:99], v[48:63]
    v_mfma_f32_32x32x16_bf16 v[64:79], v[132:135], v[100:103], v[64:79]
    s_waitcnt lgkmcnt(0)
    s_barrier
    v_mfma_f32_32x32x16_bf16 v[32:47], v[136:139], v[104:107], v[32:47]
    v_mfma_f32_32x32x16_bf16 v[48:63], v[136:139], v[108:111], v[48:63]
    v_mfma_f32_32x32x16_bf16 v[64:79], v[136:139], v[112:115], v[64:79]
    v_mfma_f32_32x32x16_bf16 v[32:47], v[140:143], v[116:119], v[32:47]
    v_mfma_f32_32x32x16_bf16 v[48:63], v[140:143], v[120:123], v[48:63]
    v_mfma_f32_32x32x16_bf16 v[64:79], v[140:143], v[124:127], v[64:79]
    s_mov_b32 s76, 0x3e0293ee
    s_mov_b32 s77, 0x3e0293ee
    s_nop 7
    s_nop 0
    v_pk_mul_f32 v[32:33], v[32:33], s[76:77]
    v_pk_mul_f32 v[34:35], v[34:35], s[76:77]
    v_pk_mul_f32 v[36:37], v[36:37], s[76:77]
    v_pk_mul_f32 v[38:39], v[38:39], s[76:77]
    v_pk_mul_f32 v[40:41], v[40:41], s[76:77]
    v_pk_mul_f32 v[42:43], v[42:43], s[76:77]
    v_pk_mul_f32 v[44:45], v[44:45], s[76:77]
    v_pk_mul_f32 v[46:47], v[46:47], s[76:77]
    v_cvt_pk_bf16_f32 v32, v32, v33
    v_cvt_pk_bf16_f32 v33, v34, v35
    v_cvt_pk_bf16_f32 v34, v36, v37
    v_cvt_pk_bf16_f32 v35, v38, v39
    v_cvt_pk_bf16_f32 v36, v40, v41
    v_cvt_pk_bf16_f32 v37, v42, v43
    v_cvt_pk_bf16_f32 v38, v44, v45
    v_cvt_pk_bf16_f32 v39, v46, v47
    ds_write_b128 v30, v[32:35] offset:0
    ds_write_b128 v30, v[36:39] offset:1024
    v_pk_mul_f32 v[48:49], v[48:49], s[76:77]
    v_pk_mul_f32 v[50:51], v[50:51], s[76:77]
    v_pk_mul_f32 v[52:53], v[52:53], s[76:77]
    v_pk_mul_f32 v[54:55], v[54:55], s[76:77]
    v_pk_mul_f32 v[56:57], v[56:57], s[76:77]
    v_pk_mul_f32 v[58:59], v[58:59], s[76:77]
    v_pk_mul_f32 v[60:61], v[60:61], s[76:77]
    v_pk_mul_f32 v[62:63], v[62:63], s[76:77]
    v_cvt_pk_bf16_f32 v48, v48, v49
    v_cvt_pk_bf16_f32 v49, v50, v51
    v_cvt_pk_bf16_f32 v50, v52, v53
    v_cvt_pk_bf16_f32 v51, v54, v55
    v_cvt_pk_bf16_f32 v52, v56, v57
    v_cvt_pk_bf16_f32 v53, v58, v59
    v_cvt_pk_bf16_f32 v54, v60, v61
    v_cvt_pk_bf16_f32 v55, v62, v63
    ds_write_b128 v30, v[48:51] offset:8192
    ds_write_b128 v30, v[52:55] offset:9216
    v_pk_mul_f32 v[64:65], v[64:65], s[76:77]
    v_pk_mul_f32 v[66:67], v[66:67], s[76:77]
    v_pk_mul_f32 v[68:69], v[68:69], s[76:77]
    v_pk_mul_f32 v[70:71], v[70:71], s[76:77]
    v_pk_mul_f32 v[72:73], v[72:73], s[76:77]
    v_pk_mul_f32 v[74:75], v[74:75], s[76:77]
    v_pk_mul_f32 v[76:77], v[76:77], s[76:77]
    v_pk_mul_f32 v[78:79], v[78:79], s[76:77]
    v_cvt_pk_bf16_f32 v64, v64, v65
    v_cvt_pk_bf16_f32 v65, v66, v67
    v_cvt_pk_bf16_f32 v66, v68, v69
    v_cvt_pk_bf16_f32 v67, v70, v71
    v_cvt_pk_bf16_f32 v68, v72, v73
    v_cvt_pk_bf16_f32 v69, v74, v75
    v_cvt_pk_bf16_f32 v70, v76, v77
    v_cvt_pk_bf16_f32 v71, v78, v79
    ds_write_b128 v30, v[64:67] offset:16384
    ds_write_b128 v30, v[68:71] offset:17408
    s_waitcnt lgkmcnt(0)
    s_cmp_eq_u32 s30, 3
    s_cbranch_scc1 L_loader
    s_cmp_gt_u32 s30, 3
    s_cbranch_scc1 L_wproj
    s_waitcnt vmcnt(0)
    s_branch L_att
L_att:
    s_setprio 2
    s_mov_b32 s73, 0x43800000
    s_mov_b32 s74, 0
    v_mov_b32 v240, 0
    v_mov_b32 v212, 0
    v_mov_b32 v213, 0
    v_mov_b32 v214, 0
    v_mov_b32 v215, 0
    v_mov_b32 v216, 0
    v_mov_b32 v217, 0
    v_mov_b32 v218, 0
    v_mov_b32 v219, 0
    v_mov_b32 v220, 0
    v_mov_b32 v221, 0
    v_mov_b32 v222, 0
    v_mov_b32 v223, 0
    v_mov_b32 v224, 0
    v_mov_b32 v225, 0
    v_mov_b32 v226, 0
    v_mov_b32 v227, 0
    s_barrier
    ds_read_b128 v[64:67], v246 offset:0
    ds_read_b128 v[128:131], v228 offset:0
    ds_read_b128 v[68:71], v246 offset:1024
    ds_read_b128 v[132:135], v229 offset:0
    ds_read_b128 v[72:75], v246 offset:2048
    ds_read_b128 v[136:139], v230 offset:0
    ds_read_b128 v[76:79], v246 offset:3072
    ds_read_b128 v[140:143], v231 offset:0
    ds_read_b128 v[80:83], v246 offset:4096
    ds_read_b128 v[144:147], v232 offset:0
    ds_read_b128 v[84:87], v246 offset:5120
    ds_read_b128 v[148:151], v233 offset:0
    ds_read_b128 v[88:91], v246 offset:6144
    ds_read_b128 v[152:155], v234 offset:0
    ds_read_b128 v[92:95], v246 offset:7168
    ds_read_b128 v[156:159], v235 offset:0
    s_waitcnt lgkmcnt(14)
    v_mfma_f32_32x32x16_bf16 v[96:111], v[128:131], v[64:67], 0
    s_waitcnt lgkmcnt(12)
    v_mfma_f32_32x32x16_bf16 v[96:111], v[132:135], v[68:71], v[96:111]
    s_waitcnt lgkmcnt(10)
    v_mfma_f32_32x32x16_bf16 v[96:111], v[136:139], v[72:75], v[96:111]
    s_waitcnt lgkmcnt(8)
    v_mfma_f32_32x32x16_bf16 v[96:111], v[140:143], v[76:79], v[96:111]
    s_waitcnt lgkmcnt(6)
    v_mfma_f32_32x32x16_bf16 v[96:111], v[144:147], v[80:83], v[96:111]
    s_waitcnt lgkmcnt(4)
    v_mfma_f32_32x32x16_bf16 v[96:111], v[148:151], v[84:87], v[96:111]
    s_waitcnt lgkmcnt(2)
    v_mfma_f32_32x32x16_bf16 v[96:111], v[152:155], v[88:91], v[96:111]
    s_waitcnt lgkmcnt(0)
    v_mfma_f32_32x32x16_bf16 v[96:111], v[156:159], v[92:95], v[96:111]
    s_nop 7
    s_waitcnt vmcnt(0)
L_att_loop:
    s_barrier
    ds_read_b128 v[128:131], v228 offset:8192
    ds_read_b128 v[132:135], v229 offset:8192
    ds_read_b128 v[136:139], v230 offset:8192
    ds_read_b128 v[140:143], v231 offset:8192
    ds_read_b128 v[144:147], v232 offset:8192
    ds_read_b128 v[148:151], v233 offset:8192
    ds_read_b128 v[152:155], v234 offset:8192
    ds_read_b128 v[156:159], v235 offset:8192
    s_and_b32 s76, s74, 15
    s_cmp_lg_u32 s76, 0
    s_cbranch_scc1 L_att0_nofirst
    v_mov_b32 v241, v240
    v_mov_b32 v240, 0
    v_max3_f32 v243, v96, v97, v98
    v_max3_f32 v244, v99, v100, v101
    v_max3_f32 v245, v102, v103, v104
    v_max3_f32 v243, v243, v105, v106
    v_max3_f32 v244, v244, v107, v108
    v_max3_f32 v245, v245, v109, v110
    v_max3_f32 v243, v243, v244, v111
    v_max_f32 v243, v243, v245
    v_mov_b32 v244, v243
    s_nop 1
    v_permlane32_swap_b32 v243, v244
    s_nop 0
    v_max_f32 v243, v243, v244
    v_sub_f32 v96, v96, v243
    v_sub_f32 v97, v97, v243
    v_sub_f32 v98, v98, v243
    v_sub_f32 v99, v99, v243
    v_sub_f32 v100, v100, v243
    v_sub_f32 v101, v101, v243
    v_sub_f32 v102, v102, v243
    v_sub_f32 v103, v103, v243
    v_sub_f32 v104, v104, v243
    v_sub_f32 v105, v105, v243
    v_sub_f32 v106, v106, v243
    v_sub_f32 v107, v107, v243
    v_sub_f32 v108, v108, v243
    v_sub_f32 v109, v109, v243
    v_sub_f32 v110, v110, v243
    v_sub_f32 v111, v111, v243
    v_sub_f32 v212, v212, v243
    v_sub_f32 v213, v213, v243
    v_sub_f32 v214, v214, v243
    v_sub_f32 v215, v215, v243
    v_sub_f32 v216, v216, v243
    v_sub_f32 v217, v217, v243
    v_sub_f32 v218, v218, v243
    v_sub_f32 v219, v219, v243
    v_sub_f32 v220, v220, v243
    v_sub_f32 v221, v221, v243
    v_sub_f32 v222, v222, v243
    v_sub_f32 v223, v223, v243
    v_sub_f32 v224, v224, v243
    v_sub_f32 v225, v225, v243
    v_sub_f32 v226, v226, v243
    v_sub_f32 v227, v227, v243
L_att0_nofirst:
    v_mfma_f32_32x32x16_bf16 v[0:15], v[160:163], v[200:203], v[0:15]
    v_exp_f32 v208, v96
    v_exp_f32 v209, v97
    v_mfma_f32_32x32x16_bf16 v[16:31], v[168:171], v[200:203], v[16:31]
    ds_read_b64_tr_b16 v[160:161], v236 offset:0
    ds_read_b64_tr_b16 v[162:163], v236 offset:2048
    ds_read_b64_tr_b16 v[168:169], v237 offset:0
    ds_read_b64_tr_b16 v[170:171], v237 offset:2048
    v_mfma_f32_32x32x16_bf16 v[32:47], v[176:179], v[200:203], v[32:47]
    v_exp_f32 v210, v98
    v_exp_f32 v211, v99
    v_add_f32 v242, v208, v209
    v_cvt_pk_bf16_f32 v192, v208, v209
    v_mfma_f32_32x32x16_bf16 v[48:63], v[184:187], v[200:203], v[48:63]
    ds_read_b64_tr_b16 v[176:177], v238 offset:0
    ds_read_b64_tr_b16 v[178:179], v238 offset:2048
    ds_read_b64_tr_b16 v[184:185], v239 offset:0
    ds_read_b64_tr_b16 v[186:187], v239 offset:2048
    v_mfma_f32_32x32x16_bf16 v[0:15], v[164:167], v[204:207], v[0:15]
    v_exp_f32 v208, v100
    v_exp_f32 v209, v101
    v_add_f32 v242, v242, v210
    v_add_f32 v242, v242, v211
    v_cvt_pk_bf16_f32 v193, v210, v211
    v_mfma_f32_32x32x16_bf16 v[16:31], v[172:175], v[204:207], v[16:31]
    ds_read_b64_tr_b16 v[164:165], v236 offset:4096
    ds_read_b64_tr_b16 v[166:167], v236 offset:6144
    ds_read_b64_tr_b16 v[172:173], v237 offset:4096
    ds_read_b64_tr_b16 v[174:175], v237 offset:6144
    v_mfma_f32_32x32x16_bf16 v[32:47], v[180:183], v[204:207], v[32:47]
    v_exp_f32 v210, v102
    v_exp_f32 v211, v103
    v_add_f32 v242, v242, v208
    v_add_f32 v242, v242, v209
    v_cvt_pk_bf16_f32 v194, v208, v209
    v_mfma_f32_32x32x16_bf16 v[48:63], v[188:191], v[204:207], v[48:63]
    ds_read_b64_tr_b16 v[180:181], v238 offset:4096
    ds_read_b64_tr_b16 v[182:183], v238 offset:6144
    ds_read_b64_tr_b16 v[188:189], v239 offset:4096
    ds_read_b64_tr_b16 v[190:191], v239 offset:6144
    s_waitcnt lgkmcnt(15)
    v_mfma_f32_32x32x16_bf16 v[112:127], v[128:131], v[64:67], v[212:227]
    v_exp_f32 v208, v104
    v_exp_f32 v209, v105
    v_add_f32 v242, v242, v210
    v_add_f32 v242, v242, v211
    v_cvt_pk_bf16_f32 v195, v210, v211
    v_mfma_f32_32x32x16_bf16 v[112:127], v[132:135], v[68:71], v[112:127]
    v_mfma_f32_32x32x16_bf16 v[112:127], v[136:139], v[72:75], v[112:127]
    v_exp_f32 v210, v106
    v_exp_f32 v211, v107
    v_add_f32 v242, v242, v208
    v_add_f32 v242, v242, v209
    v_cvt_pk_bf16_f32 v196, v208, v209
    v_mfma_f32_32x32x16_bf16 v[112:127], v[140:143], v[76:79], v[112:127]
    v_mfma_f32_32x32x16_bf16 v[112:127], v[144:147], v[80:83], v[112:127]
    v_exp_f32 v208, v108
    v_exp_f32 v209, v109
    v_add_f32 v242, v242, v210
    v_add_f32 v242, v242, v211
    v_cvt_pk_bf16_f32 v197, v210, v211
    v_mfma_f32_32x32x16_bf16 v[112:127], v[148:151], v[84:87], v[112:127]
    v_mfma_f32_32x32x16_bf16 v[112:127], v[152:155], v[88:91], v[112:127]
    v_exp_f32 v210, v110
    v_exp_f32 v211, v111
    v_add_f32 v242, v242, v208
    v_add_f32 v242, v242, v209
    v_cvt_pk_bf16_f32 v198, v208, v209
    v_mfma_f32_32x32x16_bf16 v[112:127], v[156:159], v[92:95], v[112:127]
    v_add_f32 v242, v242, v210
    v_add_f32 v242, v242, v211
    v_cvt_pk_bf16_f32 v199, v210, v211
    v_cmp_lt_f32 vcc, s73, v242
    s_cbranch_vccnz L_att0_resc
L_att0_back:
    v_add_f32 v240, v240, v242
    s_add_u32 s74, s74, 1
    s_waitcnt lgkmcnt(0)
    s_barrier
    ds_read_b128 v[128:131], v228 offset:16384
    ds_read_b128 v[132:135], v229 offset:16384
    ds_read_b128 v[136:139], v230 offset:16384
    ds_read_b128 v[140:143], v231 offset:16384
    ds_read_b128 v[144:147], v232 offset:16384
    ds_read_b128 v[148:151], v233 offset:16384
    ds_read_b128 v[152:155], v234 offset:16384
    ds_read_b128 v[156:159], v235 offset:16384
    s_and_b32 s76, s74, 15
    s_cmp_lg_u32 s76, 1
    s_cbranch_scc1 L_att1_nofin
    s_cmp_eq_u32 s74, 1
    s_cbranch_scc1 L_att1_zero
    v_mov_b32 v244, v241
    s_nop 1
    v_permlane32_swap_b32 v241, v244
    s_nop 0
    v_add_f32 v241, v241, v244
    v_rcp_f32 v245, v241
    s_nop 0
    v_mov_b32 v248, v245
    v_mov_b32 v249, v245
    v_pk_mul_f32 v[0:1], v[0:1], v[248:249]
    v_pk_mul_f32 v[2:3], v[2:3], v[248:249]
    v_pk_mul_f32 v[4:5], v[4:5], v[248:249]
    v_pk_mul_f32 v[6:7], v[6:7], v[248:249]
    v_pk_mul_f32 v[8:9], v[8:9], v[248:249]
    v_pk_mul_f32 v[10:11], v[10:11], v[248:249]
    v_pk_mul_f32 v[12:13], v[12:13], v[248:249]
    v_pk_mul_f32 v[14:15], v[14:15], v[248:249]
    v_cvt_pk_bf16_f32 v0, v0, v1
    v_cvt_pk_bf16_f32 v1, v2, v3
    v_cvt_pk_bf16_f32 v2, v4, v5
    v_cvt_pk_bf16_f32 v3, v6, v7
    v_cvt_pk_bf16_f32 v4, v8, v9
    v_cvt_pk_bf16_f32 v5, v10, v11
    v_cvt_pk_bf16_f32 v6, v12, v13
    v_cvt_pk_bf16_f32 v7, v14, v15
    v_pk_mul_f32 v[16:17], v[16:17], v[248:249]
    v_pk_mul_f32 v[18:19], v[18:19], v[248:249]
    v_pk_mul_f32 v[20:21], v[20:21], v[248:249]
    v_pk_mul_f32 v[22:23], v[22:23], v[248:249]
    v_pk_mul_f32 v[24:25], v[24:25], v[248:249]
    v_pk_mul_f32 v[26:27], v[26:27], v[248:249]
    v_pk_mul_f32 v[28:29], v[28:29], v[248:249]
    v_pk_mul_f32 v[30:31], v[30:31], v[248:249]
    v_cvt_pk_bf16_f32 v16, v16, v17
    v_cvt_pk_bf16_f32 v17, v18, v19
    v_cvt_pk_bf16_f32 v18, v20, v21
    v_cvt_pk_bf16_f32 v19, v22, v23
    v_cvt_pk_bf16_f32 v20, v24, v25
    v_cvt_pk_bf16_f32 v21, v26, v27
    v_cvt_pk_bf16_f32 v22, v28, v29
    v_cvt_pk_bf16_f32 v23, v30, v31
    v_pk_mul_f32 v[32:33], v[32:33], v[248:249]
    v_pk_mul_f32 v[34:35], v[34:35], v[248:249]
    v_pk_mul_f32 v[36:37], v[36:37], v[248:249]
    v_pk_mul_f32 v[38:39], v[38:39], v[248:249]
    v_pk_mul_f32 v[40:41], v[40:41], v[248:249]
    v_pk_mul_f32 v[42:43], v[42:43], v[248:249]
    v_pk_mul_f32 v[44:45], v[44:45], v[248:249]
    v_pk_mul_f32 v[46:47], v[46:47], v[248:249]
    v_cvt_pk_bf16_f32 v32, v32, v33
    v_cvt_pk_bf16_f32 v33, v34, v35
    v_cvt_pk_bf16_f32 v34, v36, v37
    v_cvt_pk_bf16_f32 v35, v38, v39
    v_cvt_pk_bf16_f32 v36, v40, v41
    v_cvt_pk_bf16_f32 v37, v42, v43
    v_cvt_pk_bf16_f32 v38, v44, v45
    v_cvt_pk_bf16_f32 v39, v46, v47
    v_pk_mul_f32 v[48:49], v[48:49], v[248:249]
    v_pk_mul_f32 v[50:51], v[50:51], v[248:249]
    v_pk_mul_f32 v[52:53], v[52:53], v[248:249]
    v_pk_mul_f32 v[54:55], v[54:55], v[248:249]
    v_pk_mul_f32 v[56:57], v[56:57], v[248:249]
    v_pk_mul_f32 v[58:59], v[58:59], v[248:249]
    v_pk_mul_f32 v[60:61], v[60:61], v[248:249]
    v_pk_mul_f32 v[62:63], v[62:63], v[248:249]
    v_cvt_pk_bf16_f32 v48, v48, v49
    v_cvt_pk_bf16_f32 v49, v50, v51
    v_cvt_pk_bf16_f32 v50, v52, v53
    v_cvt_pk_bf16_f32 v51, v54, v55
    v_cvt_pk_bf16_f32 v52, v56, v57
    v_cvt_pk_bf16_f32 v53, v58, v59
    v_cvt_pk_bf16_f32 v54, v60, v61
    v_cvt_pk_bf16_f32 v55, v62, v63
    ds_write_b128 v247, v[0:3] offset:0
    ds_write_b128 v247, v[4:7] offset:1024
    ds_write_b128 v247, v[16:19] offset:2048
    ds_write_b128 v247, v[20:23] offset:3072
    ds_write_b128 v247, v[32:35] offset:4096
    ds_write_b128 v247, v[36:39] offset:5120
    ds_write_b128 v247, v[48:51] offset:6144
    ds_write_b128 v247, v[52:55] offset:7168
    v_add_u32 v247, 24576, v247
    s_nop 1
L_att1_zero:
    v_mfma_f32_32x32x16_bf16 v[0:15], v[160:163], v[192:195], 0
    v_exp_f32 v208, v112
    v_exp_f32 v209, v113
    v_mfma_f32_32x32x16_bf16 v[16:31], v[168:171], v[192:195], 0
    ds_read_b64_tr_b16 v[160:161], v236 offset:8192
    ds_read_b64_tr_b16 v[162:163], v236 offset:10240
    ds_read_b64_tr_b16 v[168:169], v237 offset:8192
    ds_read_b64_tr_b16 v[170:171], v237 offset:10240
    v_mfma_f32_32x32x16_bf16 v[32:47], v[176:179], v[192:195], 0
    v_exp_f32 v210, v114
    v_exp_f32 v211, v115
    v_add_f32 v242, v208, v209
    v_cvt_pk_bf16_f32 v200, v208, v209
    v_mfma_f32_32x32x16_bf16 v[48:63], v[184:187], v[192:195], 0
    ds_read_b64_tr_b16 v[176:177], v238 offset:8192
    ds_read_b64_tr_b16 v[178:179], v238 offset:10240
    ds_read_b64_tr_b16 v[184:185], v239 offset:8192
    ds_read_b64_tr_b16 v[186:187], v239 offset:10240
    s_branch L_att1_join
L_att1_nofin:
    v_mfma_f32_32x32x16_bf16 v[0:15], v[160:163], v[192:195], v[0:15]
    v_exp_f32 v208, v112
    v_exp_f32 v209, v113
    v_mfma_f32_32x32x16_bf16 v[16:31], v[168:171], v[192:195], v[16:31]
    ds_read_b64_tr_b16 v[160:161], v236 offset:8192
    ds_read_b64_tr_b16 v[162:163], v236 offset:10240
    ds_read_b64_tr_b16 v[168:169], v237 offset:8192
    ds_read_b64_tr_b16 v[170:171], v237 offset:10240
    v_mfma_f32_32x32x16_bf16 v[32:47], v[176:179], v[192:195], v[32:47]
    v_exp_f32 v210, v114
    v_exp_f32 v211, v115
    v_add_f32 v242, v208, v209
    v_cvt_pk_bf16_f32 v200, v208, v209
    v_mfma_f32_32x32x16_bf16 v[48:63], v[184:187], v[192:195], v[48:63]
    ds_read_b64_tr_b16 v[176:177], v238 offset:8192
    ds_read_b64_tr_b16 v[178:179], v238 offset:10240
    ds_read_b64_tr_b16 v[184:185], v239 offset:8192
    ds_read_b64_tr_b16 v[186:187], v239 offset:10240
L_att1_join:
    v_mfma_f32_32x32x16_bf16 v[0:15], v[164:167], v[196:199], v[0:15]
    v_exp_f32 v208, v116
    v_exp_f32 v209, v117
    v_add_f32 v242, v242, v210
    v_add_f32 v242, v242, v211
    v_cvt_pk_bf16_f32 v201, v210, v211
    v_mfma_f32_32x32x16_bf16 v[16:31], v[172:175], v[196:199], v[16:31]
    ds_read_b64_tr_b16 v[164:165], v236 offset:12288
    ds_read_b64_tr_b16 v[166:167], v236 offset:14336
    ds_read_b64_tr_b16 v[172:173], v237 offset:12288
    ds_read_b64_tr_b16 v[174:175], v237 offset:14336
    v_mfma_f32_32x32x16_bf16 v[32:47], v[180:183], v[196:199], v[32:47]
    v_exp_f32 v210, v118
    v_exp_f32 v211, v119
    v_add_f32 v242, v242, v208
    v_add_f32 v242, v242, v209
    v_cvt_pk_bf16_f32 v202, v208, v209
    v_mfma_f32_32x32x16_bf16 v[48:63], v[188:191], v[196:199], v[48:63]
    ds_read_b64_tr_b16 v[180:181], v238 offset:12288
    ds_read_b64_tr_b16 v[182:183], v238 offset:14336
    ds_read_b64_tr_b16 v[188:189], v239 offset:12288
    ds_read_b64_tr_b16 v[190:191], v239 offset:14336
    s_waitcnt lgkmcnt(15)
    v_mfma_f32_32x32x16_bf16 v[96:111], v[128:131], v[64:67], v[212:227]
    v_exp_f32 v208, v120
    v_exp_f32 v209, v121
    v_add_f32 v242, v242, v210
    v_add_f32 v242, v242, v211
    v_cvt_pk_bf16_f32 v203, v210, v211
    v_mfma_f32_32x32x16_bf16 v[96:111], v[132:135], v[68:71], v[96:111]
    v_mfma_f32_32x32x16_bf16 v[96:111], v[136:139], v[72:75], v[96:111]
    v_exp_f32 v210, v122
    v_exp_f32 v211, v123
    v_add_f32 v242, v242, v208
    v_add_f32 v242, v242, v209
    v_cvt_pk_bf16_f32 v204, v208, v209
    v_mfma_f32_32x32x16_bf16 v[96:111], v[140:143], v[76:79], v[96:111]
    v_mfma_f32_32x32x16_bf16 v[96:111], v[144:147], v[80:83], v[96:111]
    v_exp_f32 v208, v124
    v_exp_f32 v209, v125
    v_add_f32 v242, v242, v210
    v_add_f32 v242, v242, v211
    v_cvt_pk_bf16_f32 v205, v210, v211
    v_mfma_f32_32x32x16_bf16 v[96:111], v[148:151], v[84:87], v[96:111]
    v_mfma_f32_32x32x16_bf16 v[96:111], v[152:155], v[88:91], v[96:111]
    v_exp_f32 v210, v126
    v_exp_f32 v211, v127
    v_add_f32 v242, v242, v208
    v_add_f32 v242, v242, v209
    v_cvt_pk_bf16_f32 v206, v208, v209
    v_mfma_f32_32x32x16_bf16 v[96:111], v[156:159], v[92:95], v[96:111]
    v_add_f32 v242, v242, v210
    v_add_f32 v242, v242, v211
    v_cvt_pk_bf16_f32 v207, v210, v211
    v_cmp_lt_f32 vcc, s73, v242
    s_cbranch_vccnz L_att1_resc
L_att1_back:
    v_add_f32 v240, v240, v242
    s_add_u32 s74, s74, 1
    s_waitcnt lgkmcnt(0)
    s_barrier
    ds_read_b128 v[128:131], v228 offset:24576
    ds_read_b128 v[132:135], v229 offset:24576
    ds_read_b128 v[136:139], v230 offset:24576
    ds_read_b128 v[140:143], v231 offset:24576
    ds_read_b128 v[144:147], v232 offset:24576
    ds_read_b128 v[148:151], v233 offset:24576
    ds_read_b128 v[152:155], v234 offset:24576
    ds_read_b128 v[156:159], v235 offset:24576
    v_mfma_f32_32x32x16_bf16 v[0:15], v[160:163], v[200:203], v[0:15]
    v_exp_f32 v208, v96
    v_exp_f32 v209, v97
    v_mfma_f32_32x32x16_bf16 v[16:31], v[168:171], v[200:203], v[16:31]
    ds_read_b64_tr_b16 v[160:161], v236 offset:16384
    ds_read_b64_tr_b16 v[162:163], v236 offset:18432
    ds_read_b64_tr_b16 v[168:169], v237 offset:16384
    ds_read_b64_tr_b16 v[170:171], v237 offset:18432
    v_mfma_f32_32x32x16_bf16 v[32:47], v[176:179], v[200:203], v[32:47]
    v_exp_f32 v210, v98
    v_exp_f32 v211, v99
    v_add_f32 v242, v208, v209
    v_cvt_pk_bf16_f32 v192, v208, v209
    v_mfma_f32_32x32x16_bf16 v[48:63], v[184:187], v[200:203], v[48:63]
    ds_read_b64_tr_b16 v[176:177], v238 offset:16384
    ds_read_b64_tr_b16 v[178:179], v238 offset:18432
    ds_read_b64_tr_b16 v[184:185], v239 offset:16384
    ds_read_b64_tr_b16 v[186:187], v239 offset:18432
    v_mfma_f32_32x32x16_bf16 v[0:15], v[164:167], v[204:207], v[0:15]
    v_exp_f32 v208, v100
    v_exp_f32 v209, v101
    v_add_f32 v242, v242, v210
    v_add_f32 v242, v242, v211
    v_cvt_pk_bf16_f32 v193, v210, v211
    v_mfma_f32_32x32x16_bf16 v[16:31], v[172:175], v[204:207], v[16:31]
    ds_read_b64_tr_b16 v[164:165], v236 offset:20480
    ds_read_b64_tr_b16 v[166:167], v236 offset:22528
    ds_read_b64_tr_b16 v[172:173], v237 offset:20480
    ds_read_b64_tr_b16 v[174:175], v237 offset:22528
    v_mfma_f32_32x32x16_bf16 v[32:47], v[180:183], v[204:207], v[32:47]
    v_exp_f32 v210, v102
    v_exp_f32 v211, v103
    v_add_f32 v242, v242, v208
    v_add_f32 v242, v242, v209
    v_cvt_pk_bf16_f32 v194, v208, v209
    v_mfma_f32_32x32x16_bf16 v[48:63], v[188:191], v[204:207], v[48:63]
    ds_read_b64_tr_b16 v[180:181], v238 offset:20480
    ds_read_b64_tr_b16 v[182:183], v238 offset:22528
    ds_read_b64_tr_b16 v[188:189], v239 offset:20480
    ds_read_b64_tr_b16 v[190:191], v239 offset:22528
    s_waitcnt lgkmcnt(15)
    v_mfma_f32_32x32x16_bf16 v[112:127], v[128:131], v[64:67], v[212:227]
    v_exp_f32 v208, v104
    v_exp_f32 v209, v105
    v_add_f32 v242, v242, v210
    v_add_f32 v242, v242, v211
    v_cvt_pk_bf16_f32 v195, v210, v211
    v_mfma_f32_32x32x16_bf16 v[112:127], v[132:135], v[68:71], v[112:127]
    v_mfma_f32_32x32x16_bf16 v[112:127], v[136:139], v[72:75], v[112:127]
    v_exp_f32 v210, v106
    v_exp_f32 v211, v107
    v_add_f32 v242, v242, v208
    v_add_f32 v242, v242, v209
    v_cvt_pk_bf16_f32 v196, v208, v209
    v_mfma_f32_32x32x16_bf16 v[112:127], v[140:143], v[76:79], v[112:127]
    v_mfma_f32_32x32x16_bf16 v[112:127], v[144:147], v[80:83], v[112:127]
    v_exp_f32 v208, v108
    v_exp_f32 v209, v109
    v_add_f32 v242, v242, v210
    v_add_f32 v242, v242, v211
    v_cvt_pk_bf16_f32 v197, v210, v211
    v_mfma_f32_32x32x16_bf16 v[112:127], v[148:151], v[84:87], v[112:127]
    v_mfma_f32_32x32x16_bf16 v[112:127], v[152:155], v[88:91], v[112:127]
    v_exp_f32 v210, v110
    v_exp_f32 v211, v111
    v_add_f32 v242, v242, v208
    v_add_f32 v242, v242, v209
    v_cvt_pk_bf16_f32 v198, v208, v209
    v_mfma_f32_32x32x16_bf16 v[112:127], v[156:159], v[92:95], v[112:127]
    v_add_f32 v242, v242, v210
    v_add_f32 v242, v242, v211
    v_cvt_pk_bf16_f32 v199, v210, v211
    v_cmp_lt_f32 vcc, s73, v242
    s_cbranch_vccnz L_att2_resc
L_att2_back:
    v_add_f32 v240, v240, v242
    s_add_u32 s74, s74, 1
    s_waitcnt lgkmcnt(0)
    s_barrier
    ds_read_b128 v[128:131], v228 offset:0
    ds_read_b128 v[132:135], v229 offset:0
    ds_read_b128 v[136:139], v230 offset:0
    ds_read_b128 v[140:143], v231 offset:0
    ds_read_b128 v[144:147], v232 offset:0
    ds_read_b128 v[148:151], v233 offset:0
    ds_read_b128 v[152:155], v234 offset:0
    ds_read_b128 v[156:159], v235 offset:0
    s_and_b32 s76, s74, 15
    s_cmp_lg_u32 s76, 15
    s_cbranch_scc1 L_att3_noq
    v_add_u32 v246, 24576, v246
    ds_read_b128 v[64:67], v246 offset:0
    ds_read_b128 v[68:71], v246 offset:1024
    ds_read_b128 v[72:75], v246 offset:2048
    ds_read_b128 v[76:79], v246 offset:3072
    ds_read_b128 v[80:83], v246 offset:4096
    ds_read_b128 v[84:87], v246 offset:5120
    ds_read_b128 v[88:91], v246 offset:6144
    ds_read_b128 v[92:95], v246 offset:7168
    v_mov_b32 v212, 0
    v_mov_b32 v213, 0
    v_mov_b32 v214, 0
    v_mov_b32 v215, 0
    v_mov_b32 v216, 0
    v_mov_b32 v217, 0
    v_mov_b32 v218, 0
    v_mov_b32 v219, 0
    v_mov_b32 v220, 0
    v_mov_b32 v221, 0
    v_mov_b32 v222, 0
    v_mov_b32 v223, 0
    v_mov_b32 v224, 0
    v_mov_b32 v225, 0
    v_mov_b32 v226, 0
    v_mov_b32 v227, 0
    s_waitcnt lgkmcnt(0)
L_att3_noq:
    v_mfma_f32_32x32x16_bf16 v[0:15], v[160:163], v[192:195], v[0:15]
    v_exp_f32 v208, v112
    v_exp_f32 v209, v113
    v_mfma_f32_32x32x16_bf16 v[16:31], v[168:171], v[192:195], v[16:31]
    ds_read_b64_tr_b16 v[160:161], v236 offset:24576
    ds_read_b64_tr_b16 v[162:163], v236 offset:26624
    ds_read_b64_tr_b16 v[168:169], v237 offset:24576
    ds_read_b64_tr_b16 v[170:171], v237 offset:26624
    v_mfma_f32_32x32x16_bf16 v[32:47], v[176:179], v[192:195], v[32:47]
    v_exp_f32 v210, v114
    v_exp_f32 v211, v115
    v_add_f32 v242, v208, v209
    v_cvt_pk_bf16_f32 v200, v208, v209
    v_mfma_f32_32x32x16_bf16 v[48:63], v[184:187], v[192:195], v[48:63]
    ds_read_b64_tr_b16 v[176:177], v238 offset:24576
    ds_read_b64_tr_b16 v[178:179], v238 offset:26624
    ds_read_b64_tr_b16 v[184:185], v239 offset:24576
    ds_read_b64_tr_b16 v[186:187], v239 offset:26624
    v_mfma_f32_32x32x16_bf16 v[0:15], v[164:167], v[196:199], v[0:15]
    v_exp_f32 v208, v116
    v_exp_f32 v209, v117
    v_add_f32 v242, v242, v210
    v_add_f32 v242, v242, v211
    v_cvt_pk_bf16_f32 v201, v210, v211
    v_mfma_f32_32x32x16_bf16 v[16:31], v[172:175], v[196:199], v[16:31]
    ds_read_b64_tr_b16 v[164:165], v236 offset:28672
    ds_read_b64_tr_b16 v[166:167], v236 offset:30720
    ds_read_b64_tr_b16 v[172:173], v237 offset:28672
    ds_read_b64_tr_b16 v[174:175], v237 offset:30720
    v_mfma_f32_32x32x16_bf16 v[32:47], v[180:183], v[196:199], v[32:47]
    v_exp_f32 v210, v118
    v_exp_f32 v211, v119
    v_add_f32 v242, v242, v208
    v_add_f32 v242, v242, v209
    v_cvt_pk_bf16_f32 v202, v208, v209
    v_mfma_f32_32x32x16_bf16 v[48:63], v[188:191], v[196:199], v[48:63]
    ds_read_b64_tr_b16 v[180:181], v238 offset:28672
    ds_read_b64_tr_b16 v[182:183], v238 offset:30720
    ds_read_b64_tr_b16 v[188:189], v239 offset:28672
    ds_read_b64_tr_b16 v[190:191], v239 offset:30720
    s_waitcnt lgkmcnt(15)
    v_mfma_f32_32x32x16_bf16 v[96:111], v[128:131], v[64:67], v[212:227]
    v_exp_f32 v208, v120
    v_exp_f32 v209, v121
    v_add_f32 v242, v242, v210
    v_add_f32 v242, v242, v211
    v_cvt_pk_bf16_f32 v203, v210, v211
    v_mfma_f32_32x32x16_bf16 v[96:111], v[132:135], v[68:71], v[96:111]
    v_mfma_f32_32x32x16_bf16 v[96:111], v[136:139], v[72:75], v[96:111]
    v_exp_f32 v210, v122
    v_exp_f32 v211, v123
    v_add_f32 v242, v242, v208
    v_add_f32 v242, v242, v209
    v_cvt_pk_bf16_f32 v204, v208, v209
    v_mfma_f32_32x32x16_bf16 v[96:111], v[140:143], v[76:79], v[96:111]
    v_mfma_f32_32x32x16_bf16 v[96:111], v[144:147], v[80:83], v[96:111]
    v_exp_f32 v208, v124
    v_exp_f32 v209, v125
    v_add_f32 v242, v242, v210
    v_add_f32 v242, v242, v211
    v_cvt_pk_bf16_f32 v205, v210, v211
    v_mfma_f32_32x32x16_bf16 v[96:111], v[148:151], v[84:87], v[96:111]
    v_mfma_f32_32x32x16_bf16 v[96:111], v[152:155], v[88:91], v[96:111]
    v_exp_f32 v210, v126
    v_exp_f32 v211, v127
    v_add_f32 v242, v242, v208
    v_add_f32 v242, v242, v209
    v_cvt_pk_bf16_f32 v206, v208, v209
    v_mfma_f32_32x32x16_bf16 v[96:111], v[156:159], v[92:95], v[96:111]
    v_add_f32 v242, v242, v210
    v_add_f32 v242, v242, v211
    v_cvt_pk_bf16_f32 v207, v210, v211
    v_cmp_lt_f32 vcc, s73, v242
    s_cbranch_vccnz L_att3_resc
L_att3_back:
    v_add_f32 v240, v240, v242
    s_add_u32 s74, s74, 1
    s_waitcnt lgkmcnt(0)
    s_cmp_lt_u32 s74, 64
    s_cbranch_scc1 L_att_loop
    s_barrier
    v_mfma_f32_32x32x16_bf16 v[0:15], v[160:163], v[200:203], v[0:15]
    v_mfma_f32_32x32x16_bf16 v[16:31], v[168:171], v[200:203], v[16:31]
    v_mfma_f32_32x32x16_bf16 v[32:47], v[176:179], v[200:203], v[32:47]
    v_mfma_f32_32x32x16_bf16 v[48:63], v[184:187], v[200:203], v[48:63]
    v_mfma_f32_32x32x16_bf16 v[0:15], v[164:167], v[204:207], v[0:15]
    v_mfma_f32_32x32x16_bf16 v[16:31], v[172:175], v[204:207], v[16:31]
    v_mfma_f32_32x32x16_bf16 v[32:47], v[180:183], v[204:207], v[32:47]
    v_mfma_f32_32x32x16_bf16 v[48:63], v[188:191], v[204:207], v[48:63]
    v_mov_b32 v241, v240
    v_subrev_u32 v247, 73728, v247
    s_nop 7
    s_nop 2
    v_mov_b32 v244, v241
    s_nop 1
    v_permlane32_swap_b32 v241, v244
    s_nop 0
    v_add_f32 v241, v241, v244
    v_rcp_f32 v245, v241
    s_nop 0
    v_mov_b32 v248, v245
    v_mov_b32 v249, v245
    v_pk_mul_f32 v[0:1], v[0:1], v[248:249]
    v_pk_mul_f32 v[2:3], v[2:3], v[248:249]
    v_pk_mul_f32 v[4:5], v[4:5], v[248:249]
    v_pk_mul_f32 v[6:7], v[6:7], v[248:249]
    v_pk_mul_f32 v[8:9], v[8:9], v[248:249]
    v_pk_mul_f32 v[10:11], v[10:11], v[248:249]
    v_pk_mul_f32 v[12:13], v[12:13], v[248:249]
    v_pk_mul_f32 v[14:15], v[14:15], v[248:249]
    v_cvt_pk_bf16_f32 v0, v0, v1
    v_cvt_pk_bf16_f32 v1, v2, v3
    v_cvt_pk_bf16_f32 v2, v4, v5
    v_cvt_pk_bf16_f32 v3, v6, v7
    v_cvt_pk_bf16_f32 v4, v8, v9
    v_cvt_pk_bf16_f32 v5, v10, v11
    v_cvt_pk_bf16_f32 v6, v12, v13
    v_cvt_pk_bf16_f32 v7, v14, v15
    v_pk_mul_f32 v[16:17], v[16:17], v[248:249]
    v_pk_mul_f32 v[18:19], v[18:19], v[248:249]
    v_pk_mul_f32 v[20:21], v[20:21], v[248:249]
    v_pk_mul_f32 v[22:23], v[22:23], v[248:249]
    v_pk_mul_f32 v[24:25], v[24:25], v[248:249]
    v_pk_mul_f32 v[26:27], v[26:27], v[248:249]
    v_pk_mul_f32 v[28:29], v[28:29], v[248:249]
    v_pk_mul_f32 v[30:31], v[30:31], v[248:249]
    v_cvt_pk_bf16_f32 v16, v16, v17
    v_cvt_pk_bf16_f32 v17, v18, v19
    v_cvt_pk_bf16_f32 v18, v20, v21
    v_cvt_pk_bf16_f32 v19, v22, v23
    v_cvt_pk_bf16_f32 v20, v24, v25
    v_cvt_pk_bf16_f32 v21, v26, v27
    v_cvt_pk_bf16_f32 v22, v28, v29
    v_cvt_pk_bf16_f32 v23, v30, v31
    v_pk_mul_f32 v[32:33], v[32:33], v[248:249]
    v_pk_mul_f32 v[34:35], v[34:35], v[248:249]
    v_pk_mul_f32 v[36:37], v[36:37], v[248:249]
    v_pk_mul_f32 v[38:39], v[38:39], v[248:249]
    v_pk_mul_f32 v[40:41], v[40:41], v[248:249]
    v_pk_mul_f32 v[42:43], v[42:43], v[248:249]
    v_pk_mul_f32 v[44:45], v[44:45], v[248:249]
    v_pk_mul_f32 v[46:47], v[46:47], v[248:249]
    v_cvt_pk_bf16_f32 v32, v32, v33
    v_cvt_pk_bf16_f32 v33, v34, v35
    v_cvt_pk_bf16_f32 v34, v36, v37
    v_cvt_pk_bf16_f32 v35, v38, v39
    v_cvt_pk_bf16_f32 v36, v40, v41
    v_cvt_pk_bf16_f32 v37, v42, v43
    v_cvt_pk_bf16_f32 v38, v44, v45
    v_cvt_pk_bf16_f32 v39, v46, v47
    v_pk_mul_f32 v[48:49], v[48:49], v[248:249]
    v_pk_mul_f32 v[50:51], v[50:51], v[248:249]
    v_pk_mul_f32 v[52:53], v[52:53], v[248:249]
    v_pk_mul_f32 v[54:55], v[54:55], v[248:249]
    v_pk_mul_f32 v[56:57], v[56:57], v[248:249]
    v_pk_mul_f32 v[58:59], v[58:59], v[248:249]
    v_pk_mul_f32 v[60:61], v[60:61], v[248:249]
    v_pk_mul_f32 v[62:63], v[62:63], v[248:249]
    v_cvt_pk_bf16_f32 v48, v48, v49
    v_cvt_pk_bf16_f32 v49, v50, v51
    v_cvt_pk_bf16_f32 v50, v52, v53
    v_cvt_pk_bf16_f32 v51, v54, v55
    v_cvt_pk_bf16_f32 v52, v56, v57
    v_cvt_pk_bf16_f32 v53, v58, v59
    v_cvt_pk_bf16_f32 v54, v60, v61
    v_cvt_pk_bf16_f32 v55, v62, v63
    ds_write_b128 v247, v[0:3] offset:0
    ds_write_b128 v247, v[4:7] offset:1024
    ds_write_b128 v247, v[16:19] offset:2048
    ds_write_b128 v247, v[20:23] offset:3072
    ds_write_b128 v247, v[32:35] offset:4096
    ds_write_b128 v247, v[36:39] offset:5120
    ds_write_b128 v247, v[48:51] offset:6144
    ds_write_b128 v247, v[52:55] offset:7168
    s_waitcnt lgkmcnt(0)
    s_barrier
    s_barrier
    s_branch L_reduce
L_att0_resc:
    s_nop 15
    s_nop 7
    v_max3_f32 v243, v96, v97, v98
    v_max3_f32 v244, v99, v100, v101
    v_max3_f32 v245, v102, v103, v104
    v_max3_f32 v243, v243, v105, v106
    v_max3_f32 v244, v244, v107, v108
    v_max3_f32 v245, v245, v109, v110
    v_max3_f32 v243, v243, v244, v111
    v_max_f32 v243, v243, v245
    v_mov_b32 v244, v243
    s_nop 1
    v_permlane32_swap_b32 v243, v244
    s_nop 0
    v_max_f32 v243, v243, v244
    v_max_f32 v243, 0, v243
    v_sub_f32 v244, 0, v243
    v_exp_f32 v244, v244
    s_nop 0
    v_mul_f32 v240, v240, v244
    v_mul_f32 v0, v244, v0
    v_mul_f32 v1, v244, v1
    v_mul_f32 v2, v244, v2
    v_mul_f32 v3, v244, v3
    v_mul_f32 v4, v244, v4
    v_mul_f32 v5, v244, v5
    v_mul_f32 v6, v244, v6
    v_mul_f32 v7, v244, v7
    v_mul_f32 v8, v244, v8
    v_mul_f32 v9, v244, v9
    v_mul_f32 v10, v244, v10
    v_mul_f32 v11, v244, v11
    v_mul_f32 v12, v244, v12
    v_mul_f32 v13, v244, v13
    v_mul_f32 v14, v244, v14
    v_mul_f32 v15, v244, v15
    v_mul_f32 v16, v244, v16
    v_mul_f32 v17, v244, v17
    v_mul_f32 v18, v244, v18
    v_mul_f32 v19, v244, v19
    v_mul_f32 v20, v244, v20
    v_mul_f32 v21, v244, v21
    v_mul_f32 v22, v244, v22
    v_mul_f32 v23, v244, v23
    v_mul_f32 v24, v244, v24
    v_mul_f32 v25, v244, v25
    v_mul_f32 v26, v244, v26
    v_mul_f32 v27, v244, v27
    v_mul_f32 v28, v244, v28
    v_mul_f32 v29, v244, v29
    v_mul_f32 v30, v244, v30
    v_mul_f32 v31, v244, v31
    v_mul_f32 v32, v244, v32
    v_mul_f32 v33, v244, v33
    v_mul_f32 v34, v244, v34
    v_mul_f32 v35, v244, v35
    v_mul_f32 v36, v244, v36
    v_mul_f32 v37, v244, v37
    v_mul_f32 v38, v244, v38
    v_mul_f32 v39, v244, v39
    v_mul_f32 v40, v244, v40
    v_mul_f32 v41, v244, v41
    v_mul_f32 v42, v244, v42
    v_mul_f32 v43, v244, v43
    v_mul_f32 v44, v244, v44
    v_mul_f32 v45, v244, v45
    v_mul_f32 v46, v244, v46
    v_mul_f32 v47, v244, v47
    v_mul_f32 v48, v244, v48
    v_mul_f32 v49, v244, v49
    v_mul_f32 v50, v244, v50
    v_mul_f32 v51, v244, v51
    v_mul_f32 v52, v244, v52
    v_mul_f32 v53, v244, v53
    v_mul_f32 v54, v244, v54
    v_mul_f32 v55, v244, v55
    v_mul_f32 v56, v244, v56
    v_mul_f32 v57, v244, v57
    v_mul_f32 v58, v244, v58
    v_mul_f32 v59, v244, v59
    v_mul_f32 v60, v244, v60
    v_mul_f32 v61, v244, v61
    v_mul_f32 v62, v244, v62
    v_mul_f32 v63, v244, v63
    v_sub_f32 v96, v96, v243
    v_sub_f32 v112, v112, v243
    v_sub_f32 v212, v212, v243
    v_sub_f32 v97, v97, v243
    v_sub_f32 v113, v113, v243
    v_sub_f32 v213, v213, v243
    v_sub_f32 v98, v98, v243
    v_sub_f32 v114, v114, v243
    v_sub_f32 v214, v214, v243
    v_sub_f32 v99, v99, v243
    v_sub_f32 v115, v115, v243
    v_sub_f32 v215, v215, v243
    v_sub_f32 v100, v100, v243
    v_sub_f32 v116, v116, v243
    v_sub_f32 v216, v216, v243
    v_sub_f32 v101, v101, v243
    v_sub_f32 v117, v117, v243
    v_sub_f32 v217, v217, v243
    v_sub_f32 v102, v102, v243
    v_sub_f32 v118, v118, v243
    v_sub_f32 v218, v218, v243
    v_sub_f32 v103, v103, v243
    v_sub_f32 v119, v119, v243
    v_sub_f32 v219, v219, v243
    v_sub_f32 v104, v104, v243
    v_sub_f32 v120, v120, v243
    v_sub_f32 v220, v220, v243
    v_sub_f32 v105, v105, v243
    v_sub_f32 v121, v121, v243
    v_sub_f32 v221, v221, v243
    v_sub_f32 v106, v106, v243
    v_sub_f32 v122, v122, v243
    v_sub_f32 v222, v222, v243
    v_sub_f32 v107, v107, v243
    v_sub_f32 v123, v123, v243
    v_sub_f32 v223, v223, v243
    v_sub_f32 v108, v108, v243
    v_sub_f32 v124, v124, v243
    v_sub_f32 v224, v224, v243
    v_sub_f32 v109, v109, v243
    v_sub_f32 v125, v125, v243
    v_sub_f32 v225, v225, v243
    v_sub_f32 v110, v110, v243
    v_sub_f32 v126, v126, v243
    v_sub_f32 v226, v226, v243
    v_sub_f32 v111, v111, v243
    v_sub_f32 v127, v127, v243
    v_sub_f32 v227, v227, v243
    v_exp_f32 v208, v96
    v_exp_f32 v209, v97
    s_nop 0
    v_add_f32 v242, v208, v209
    v_cvt_pk_bf16_f32 v192, v208, v209
    v_exp_f32 v208, v98
    v_exp_f32 v209, v99
    s_nop 0
    v_add_f32 v242, v242, v208
    v_add_f32 v242, v242, v209
    v_cvt_pk_bf16_f32 v193, v208, v209
    v_exp_f32 v208, v100
    v_exp_f32 v209, v101
    s_nop 0
    v_add_f32 v242, v242, v208
    v_add_f32 v242, v242, v209
    v_cvt_pk_bf16_f32 v194, v208, v209
    v_exp_f32 v208, v102
    v_exp_f32 v209, v103
    s_nop 0
    v_add_f32 v242, v242, v208
    v_add_f32 v242, v242, v209
    v_cvt_pk_bf16_f32 v195, v208, v209
    v_exp_f32 v208, v104
    v_exp_f32 v209, v105
    s_nop 0
    v_add_f32 v242, v242, v208
    v_add_f32 v242, v242, v209
    v_cvt_pk_bf16_f32 v196, v208, v209
    v_exp_f32 v208, v106
    v_exp_f32 v209, v107
    s_nop 0
    v_add_f32 v242, v242, v208
    v_add_f32 v242, v242, v209
    v_cvt_pk_bf16_f32 v197, v208, v209
    v_exp_f32 v208, v108
    v_exp_f32 v209, v109
    s_nop 0
    v_add_f32 v242, v242, v208
    v_add_f32 v242, v242, v209
    v_cvt_pk_bf16_f32 v198, v208, v209
    v_exp_f32 v208, v110
    v_exp_f32 v209, v111
    s_nop 0
    v_add_f32 v242, v242, v208
    v_add_f32 v242, v242, v209
    v_cvt_pk_bf16_f32 v199, v208, v209
    s_branch L_att0_back
L_att1_resc:
    s_nop 15
    s_nop 7
    v_max3_f32 v243, v112, v113, v114
    v_max3_f32 v244, v115, v116, v117
    v_max3_f32 v245, v118, v119, v120
    v_max3_f32 v243, v243, v121, v122
    v_max3_f32 v244, v244, v123, v124
    v_max3_f32 v245, v245, v125, v126
    v_max3_f32 v243, v243, v244, v127
    v_max_f32 v243, v243, v245
    v_mov_b32 v244, v243
    s_nop 1
    v_permlane32_swap_b32 v243, v244
    s_nop 0
    v_max_f32 v243, v243, v244
    v_max_f32 v243, 0, v243
    v_sub_f32 v244, 0, v243
    v_exp_f32 v244, v244
    s_nop 0
    v_mul_f32 v240, v240, v244
    v_mul_f32 v0, v244, v0
    v_mul_f32 v1, v244, v1
    v_mul_f32 v2, v244, v2
    v_mul_f32 v3, v244, v3
    v_mul_f32 v4, v244, v4
    v_mul_f32 v5, v244, v5
    v_mul_f32 v6, v244, v6
    v_mul_f32 v7, v244, v7
    v_mul_f32 v8, v244, v8
    v_mul_f32 v9, v244, v9
    v_mul_f32 v10, v244, v10
    v_mul_f32 v11, v244, v11
    v_mul_f32 v12, v244, v12
    v_mul_f32 v13, v244, v13
    v_mul_f32 v14, v244, v14
    v_mul_f32 v15, v244, v15
    v_mul_f32 v16, v244, v16
    v_mul_f32 v17, v244, v17
    v_mul_f32 v18, v244, v18
    v_mul_f32 v19, v244, v19
    v_mul_f32 v20, v244, v20
    v_mul_f32 v21, v244, v21
    v_mul_f32 v22, v244, v22
    v_mul_f32 v23, v244, v23
    v_mul_f32 v24, v244, v24
    v_mul_f32 v25, v244, v25
    v_mul_f32 v26, v244, v26
    v_mul_f32 v27, v244, v27
    v_mul_f32 v28, v244, v28
    v_mul_f32 v29, v244, v29
    v_mul_f32 v30, v244, v30
    v_mul_f32 v31, v244, v31
    v_mul_f32 v32, v244, v32
    v_mul_f32 v33, v244, v33
    v_mul_f32 v34, v244, v34
    v_mul_f32 v35, v244, v35
    v_mul_f32 v36, v244, v36
    v_mul_f32 v37, v244, v37
    v_mul_f32 v38, v244, v38
    v_mul_f32 v39, v244, v39
    v_mul_f32 v40, v244, v40
    v_mul_f32 v41, v244, v41
    v_mul_f32 v42, v244, v42
    v_mul_f32 v43, v244, v43
    v_mul_f32 v44, v244, v44
    v_mul_f32 v45, v244, v45
    v_mul_f32 v46, v244, v46
    v_mul_f32 v47, v244, v47
    v_mul_f32 v48, v244, v48
    v_mul_f32 v49, v244, v49
    v_mul_f32 v50, v244, v50
    v_mul_f32 v51, v244, v51
    v_mul_f32 v52, v244, v52
    v_mul_f32 v53, v244, v53
    v_mul_f32 v54, v244, v54
    v_mul_f32 v55, v244, v55
    v_mul_f32 v56, v244, v56
    v_mul_f32 v57, v244, v57
    v_mul_f32 v58, v244, v58
    v_mul_f32 v59, v244, v59
    v_mul_f32 v60, v244, v60
    v_mul_f32 v61, v244, v61
    v_mul_f32 v62, v244, v62
    v_mul_f32 v63, v244, v63
    v_sub_f32 v112, v112, v243
    v_sub_f32 v96, v96, v243
    v_sub_f32 v212, v212, v243
    v_sub_f32 v113, v113, v243
    v_sub_f32 v97, v97, v243
    v_sub_f32 v213, v213, v243
    v_sub_f32 v114, v114, v243
    v_sub_f32 v98, v98, v243
    v_sub_f32 v214, v214, v243
    v_sub_f32 v115, v115, v243
    v_sub_f32 v99, v99, v243
    v_sub_f32 v215, v215, v243
    v_sub_f32 v116, v116, v243
    v_sub_f32 v100, v100, v243
    v_sub_f32 v216, v216, v243
    v_sub_f32 v117, v117, v243
    v_sub_f32 v101, v101, v243
    v_sub_f32 v217, v217, v243
    v_sub_f32 v118, v118, v243
    v_sub_f32 v102, v102, v243
    v_sub_f32 v218, v218, v243
    v_sub_f32 v119, v119, v243
    v_sub_f32 v103, v103, v243
    v_sub_f32 v219, v219, v243
    v_sub_f32 v120, v120, v243
    v_sub_f32 v104, v104, v243
    v_sub_f32 v220, v220, v243
    v_sub_f32 v121, v121, v243
    v_sub_f32 v105, v105, v243
    v_sub_f32 v221, v221, v243
    v_sub_f32 v122, v122, v243
    v_sub_f32 v106, v106, v243
    v_sub_f32 v222, v222, v243
    v_sub_f32 v123, v123, v243
    v_sub_f32 v107, v107, v243
    v_sub_f32 v223, v223, v243
    v_sub_f32 v124, v124, v243
    v_sub_f32 v108, v108, v243
    v_sub_f32 v224, v224, v243
    v_sub_f32 v125, v125, v243
    v_sub_f32 v109, v109, v243
    v_sub_f32 v225, v225, v243
    v_sub_f32 v126, v126, v243
    v_sub_f32 v110, v110, v243
    v_sub_f32 v226, v226, v243
    v_sub_f32 v127, v127, v243
    v_sub_f32 v111, v111, v243
    v_sub_f32 v227, v227, v243
    v_exp_f32 v208, v112
    v_exp_f32 v209, v113
    s_nop 0
    v_add_f32 v242, v208, v209
    v_cvt_pk_bf16_f32 v200, v208, v209
    v_exp_f32 v208, v114
    v_exp_f32 v209, v115
    s_nop 0
    v_add_f32 v242, v242, v208
    v_add_f32 v242, v242, v209
    v_cvt_pk_bf16_f32 v201, v208, v209
    v_exp_f32 v208, v116
    v_exp_f32 v209, v117
    s_nop 0
    v_add_f32 v242, v242, v208
    v_add_f32 v242, v242, v209
    v_cvt_pk_bf16_f32 v202, v208, v209
    v_exp_f32 v208, v118
    v_exp_f32 v209, v119
    s_nop 0
    v_add_f32 v242, v242, v208
    v_add_f32 v242, v242, v209
    v_cvt_pk_bf16_f32 v203, v208, v209
    v_exp_f32 v208, v120
    v_exp_f32 v209, v121
    s_nop 0
    v_add_f32 v242, v242, v208
    v_add_f32 v242, v242, v209
    v_cvt_pk_bf16_f32 v204, v208, v209
    v_exp_f32 v208, v122
    v_exp_f32 v209, v123
    s_nop 0
    v_add_f32 v242, v242, v208
    v_add_f32 v242, v242, v209
    v_cvt_pk_bf16_f32 v205, v208, v209
    v_exp_f32 v208, v124
    v_exp_f32 v209, v125
    s_nop 0
    v_add_f32 v242, v242, v208
    v_add_f32 v242, v242, v209
    v_cvt_pk_bf16_f32 v206, v208, v209
    v_exp_f32 v208, v126
    v_exp_f32 v209, v127
    s_nop 0
    v_add_f32 v242, v242, v208
    v_add_f32 v242, v242, v209
    v_cvt_pk_bf16_f32 v207, v208, v209
    s_branch L_att1_back
L_att2_resc:
    s_nop 15
    s_nop 7
    v_max3_f32 v243, v96, v97, v98
    v_max3_f32 v244, v99, v100, v101
    v_max3_f32 v245, v102, v103, v104
    v_max3_f32 v243, v243, v105, v106
    v_max3_f32 v244, v244, v107, v108
    v_max3_f32 v245, v245, v109, v110
    v_max3_f32 v243, v243, v244, v111
    v_max_f32 v243, v243, v245
    v_mov_b32 v244, v243
    s_nop 1
    v_permlane32_swap_b32 v243, v244
    s_nop 0
    v_max_f32 v243, v243, v244
    v_max_f32 v243, 0, v243
    v_sub_f32 v244, 0, v243
    v_exp_f32 v244, v244
    s_nop 0
    v_mul_f32 v240, v240, v244
    v_mul_f32 v0, v244, v0
    v_mul_f32 v1, v244, v1
    v_mul_f32 v2, v244, v2
    v_mul_f32 v3, v244, v3
    v_mul_f32 v4, v244, v4
    v_mul_f32 v5, v244, v5
    v_mul_f32 v6, v244, v6
    v_mul_f32 v7, v244, v7
    v_mul_f32 v8, v244, v8
    v_mul_f32 v9, v244, v9
    v_mul_f32 v10, v244, v10
    v_mul_f32 v11, v244, v11
    v_mul_f32 v12, v244, v12
    v_mul_f32 v13, v244, v13
    v_mul_f32 v14, v244, v14
    v_mul_f32 v15, v244, v15
    v_mul_f32 v16, v244, v16
    v_mul_f32 v17, v244, v17
    v_mul_f32 v18, v244, v18
    v_mul_f32 v19, v244, v19
    v_mul_f32 v20, v244, v20
    v_mul_f32 v21, v244, v21
    v_mul_f32 v22, v244, v22
    v_mul_f32 v23, v244, v23
    v_mul_f32 v24, v244, v24
    v_mul_f32 v25, v244, v25
    v_mul_f32 v26, v244, v26
    v_mul_f32 v27, v244, v27
    v_mul_f32 v28, v244, v28
    v_mul_f32 v29, v244, v29
    v_mul_f32 v30, v244, v30
    v_mul_f32 v31, v244, v31
    v_mul_f32 v32, v244, v32
    v_mul_f32 v33, v244, v33
    v_mul_f32 v34, v244, v34
    v_mul_f32 v35, v244, v35
    v_mul_f32 v36, v244, v36
    v_mul_f32 v37, v244, v37
    v_mul_f32 v38, v244, v38
    v_mul_f32 v39, v244, v39
    v_mul_f32 v40, v244, v40
    v_mul_f32 v41, v244, v41
    v_mul_f32 v42, v244, v42
    v_mul_f32 v43, v244, v43
    v_mul_f32 v44, v244, v44
    v_mul_f32 v45, v244, v45
    v_mul_f32 v46, v244, v46
    v_mul_f32 v47, v244, v47
    v_mul_f32 v48, v244, v48
    v_mul_f32 v49, v244, v49
    v_mul_f32 v50, v244, v50
    v_mul_f32 v51, v244, v51
    v_mul_f32 v52, v244, v52
    v_mul_f32 v53, v244, v53
    v_mul_f32 v54, v244, v54
    v_mul_f32 v55, v244, v55
    v_mul_f32 v56, v244, v56
    v_mul_f32 v57, v244, v57
    v_mul_f32 v58, v244, v58
    v_mul_f32 v59, v244, v59
    v_mul_f32 v60, v244, v60
    v_mul_f32 v61, v244, v61
    v_mul_f32 v62, v244, v62
    v_mul_f32 v63, v244, v63
    v_sub_f32 v96, v96, v243
    v_sub_f32 v112, v112, v243
    v_sub_f32 v212, v212, v243
    v_sub_f32 v97, v97, v243
    v_sub_f32 v113, v113, v243
    v_sub_f32 v213, v213, v243
    v_sub_f32 v98, v98, v243
    v_sub_f32 v114, v114, v243
    v_sub_f32 v214, v214, v243
    v_sub_f32 v99, v99, v243
    v_sub_f32 v115, v115, v243
    v_sub_f32 v215, v215, v243
    v_sub_f32 v100, v100, v243
    v_sub_f32 v116, v116, v243
    v_sub_f32 v216, v216, v243
    v_sub_f32 v101, v101, v243
    v_sub_f32 v117, v117, v243
    v_sub_f32 v217, v217, v243
    v_sub_f32 v102, v102, v243
    v_sub_f32 v118, v118, v243
    v_sub_f32 v218, v218, v243
    v_sub_f32 v103, v103, v243
    v_sub_f32 v119, v119, v243
    v_sub_f32 v219, v219, v243
    v_sub_f32 v104, v104, v243
    v_sub_f32 v120, v120, v243
    v_sub_f32 v220, v220, v243
    v_sub_f32 v105, v105, v243
    v_sub_f32 v121, v121, v243
    v_sub_f32 v221, v221, v243
    v_sub_f32 v106, v106, v243
    v_sub_f32 v122, v122, v243
    v_sub_f32 v222, v222, v243
    v_sub_f32 v107, v107, v243
    v_sub_f32 v123, v123, v243
    v_sub_f32 v223, v223, v243
    v_sub_f32 v108, v108, v243
    v_sub_f32 v124, v124, v243
    v_sub_f32 v224, v224, v243
    v_sub_f32 v109, v109, v243
    v_sub_f32 v125, v125, v243
    v_sub_f32 v225, v225, v243
    v_sub_f32 v110, v110, v243
    v_sub_f32 v126, v126, v243
    v_sub_f32 v226, v226, v243
    v_sub_f32 v111, v111, v243
    v_sub_f32 v127, v127, v243
    v_sub_f32 v227, v227, v243
    v_exp_f32 v208, v96
    v_exp_f32 v209, v97
    s_nop 0
    v_add_f32 v242, v208, v209
    v_cvt_pk_bf16_f32 v192, v208, v209
    v_exp_f32 v208, v98
    v_exp_f32 v209, v99
    s_nop 0
    v_add_f32 v242, v242, v208
    v_add_f32 v242, v242, v209
    v_cvt_pk_bf16_f32 v193, v208, v209
    v_exp_f32 v208, v100
    v_exp_f32 v209, v101
    s_nop 0
    v_add_f32 v242, v242, v208
    v_add_f32 v242, v242, v209
    v_cvt_pk_bf16_f32 v194, v208, v209
    v_exp_f32 v208, v102
    v_exp_f32 v209, v103
    s_nop 0
    v_add_f32 v242, v242, v208
    v_add_f32 v242, v242, v209
    v_cvt_pk_bf16_f32 v195, v208, v209
    v_exp_f32 v208, v104
    v_exp_f32 v209, v105
    s_nop 0
    v_add_f32 v242, v242, v208
    v_add_f32 v242, v242, v209
    v_cvt_pk_bf16_f32 v196, v208, v209
    v_exp_f32 v208, v106
    v_exp_f32 v209, v107
    s_nop 0
    v_add_f32 v242, v242, v208
    v_add_f32 v242, v242, v209
    v_cvt_pk_bf16_f32 v197, v208, v209
    v_exp_f32 v208, v108
    v_exp_f32 v209, v109
    s_nop 0
    v_add_f32 v242, v242, v208
    v_add_f32 v242, v242, v209
    v_cvt_pk_bf16_f32 v198, v208, v209
    v_exp_f32 v208, v110
    v_exp_f32 v209, v111
    s_nop 0
    v_add_f32 v242, v242, v208
    v_add_f32 v242, v242, v209
    v_cvt_pk_bf16_f32 v199, v208, v209
    s_branch L_att2_back
L_att3_resc:
    s_nop 15
    s_nop 7
    v_max3_f32 v243, v112, v113, v114
    v_max3_f32 v244, v115, v116, v117
    v_max3_f32 v245, v118, v119, v120
    v_max3_f32 v243, v243, v121, v122
    v_max3_f32 v244, v244, v123, v124
    v_max3_f32 v245, v245, v125, v126
    v_max3_f32 v243, v243, v244, v127
    v_max_f32 v243, v243, v245
    v_mov_b32 v244, v243
    s_nop 1
    v_permlane32_swap_b32 v243, v244
    s_nop 0
    v_max_f32 v243, v243, v244
    v_max_f32 v243, 0, v243
    v_sub_f32 v244, 0, v243
    v_exp_f32 v244, v244
    s_nop 0
    v_mul_f32 v240, v240, v244
    v_mul_f32 v0, v244, v0
    v_mul_f32 v1, v244, v1
    v_mul_f32 v2, v244, v2
    v_mul_f32 v3, v244, v3
    v_mul_f32 v4, v244, v4
    v_mul_f32 v5, v244, v5
    v_mul_f32 v6, v244, v6
    v_mul_f32 v7, v244, v7
    v_mul_f32 v8, v244, v8
    v_mul_f32 v9, v244, v9
    v_mul_f32 v10, v244, v10
    v_mul_f32 v11, v244, v11
    v_mul_f32 v12, v244, v12
    v_mul_f32 v13, v244, v13
    v_mul_f32 v14, v244, v14
    v_mul_f32 v15, v244, v15
    v_mul_f32 v16, v244, v16
    v_mul_f32 v17, v244, v17
    v_mul_f32 v18, v244, v18
    v_mul_f32 v19, v244, v19
    v_mul_f32 v20, v244, v20
    v_mul_f32 v21, v244, v21
    v_mul_f32 v22, v244, v22
    v_mul_f32 v23, v244, v23
    v_mul_f32 v24, v244, v24
    v_mul_f32 v25, v244, v25
    v_mul_f32 v26, v244, v26
    v_mul_f32 v27, v244, v27
    v_mul_f32 v28, v244, v28
    v_mul_f32 v29, v244, v29
    v_mul_f32 v30, v244, v30
    v_mul_f32 v31, v244, v31
    v_mul_f32 v32, v244, v32
    v_mul_f32 v33, v244, v33
    v_mul_f32 v34, v244, v34
    v_mul_f32 v35, v244, v35
    v_mul_f32 v36, v244, v36
    v_mul_f32 v37, v244, v37
    v_mul_f32 v38, v244, v38
    v_mul_f32 v39, v244, v39
    v_mul_f32 v40, v244, v40
    v_mul_f32 v41, v244, v41
    v_mul_f32 v42, v244, v42
    v_mul_f32 v43, v244, v43
    v_mul_f32 v44, v244, v44
    v_mul_f32 v45, v244, v45
    v_mul_f32 v46, v244, v46
    v_mul_f32 v47, v244, v47
    v_mul_f32 v48, v244, v48
    v_mul_f32 v49, v244, v49
    v_mul_f32 v50, v244, v50
    v_mul_f32 v51, v244, v51
    v_mul_f32 v52, v244, v52
    v_mul_f32 v53, v244, v53
    v_mul_f32 v54, v244, v54
    v_mul_f32 v55, v244, v55
    v_mul_f32 v56, v244, v56
    v_mul_f32 v57, v244, v57
    v_mul_f32 v58, v244, v58
    v_mul_f32 v59, v244, v59
    v_mul_f32 v60, v244, v60
    v_mul_f32 v61, v244, v61
    v_mul_f32 v62, v244, v62
    v_mul_f32 v63, v244, v63
    v_sub_f32 v112, v112, v243
    v_sub_f32 v96, v96, v243
    v_sub_f32 v212, v212, v243
    v_sub_f32 v113, v113, v243
    v_sub_f32 v97, v97, v243
    v_sub_f32 v213, v213, v243
    v_sub_f32 v114, v114, v243
    v_sub_f32 v98, v98, v243
    v_sub_f32 v214, v214, v243
    v_sub_f32 v115, v115, v243
    v_sub_f32 v99, v99, v243
    v_sub_f32 v215, v215, v243
    v_sub_f32 v116, v116, v243
    v_sub_f32 v100, v100, v243
    v_sub_f32 v216, v216, v243
    v_sub_f32 v117, v117, v243
    v_sub_f32 v101, v101, v243
    v_sub_f32 v217, v217, v243
    v_sub_f32 v118, v118, v243
    v_sub_f32 v102, v102, v243
    v_sub_f32 v218, v218, v243
    v_sub_f32 v119, v119, v243
    v_sub_f32 v103, v103, v243
    v_sub_f32 v219, v219, v243
    v_sub_f32 v120, v120, v243
    v_sub_f32 v104, v104, v243
    v_sub_f32 v220, v220, v243
    v_sub_f32 v121, v121, v243
    v_sub_f32 v105, v105, v243
    v_sub_f32 v221, v221, v243
    v_sub_f32 v122, v122, v243
    v_sub_f32 v106, v106, v243
    v_sub_f32 v222, v222, v243
    v_sub_f32 v123, v123, v243
    v_sub_f32 v107, v107, v243
    v_sub_f32 v223, v223, v243
    v_sub_f32 v124, v124, v243
    v_sub_f32 v108, v108, v243
    v_sub_f32 v224, v224, v243
    v_sub_f32 v125, v125, v243
    v_sub_f32 v109, v109, v243
    v_sub_f32 v225, v225, v243
    v_sub_f32 v126, v126, v243
    v_sub_f32 v110, v110, v243
    v_sub_f32 v226, v226, v243
    v_sub_f32 v127, v127, v243
    v_sub_f32 v111, v111, v243
    v_sub_f32 v227, v227, v243
    v_exp_f32 v208, v112
    v_exp_f32 v209, v113
    s_nop 0
    v_add_f32 v242, v208, v209
    v_cvt_pk_bf16_f32 v200, v208, v209
    v_exp_f32 v208, v114
    v_exp_f32 v209, v115
    s_nop 0
    v_add_f32 v242, v242, v208
    v_add_f32 v242, v242, v209
    v_cvt_pk_bf16_f32 v201, v208, v209
    v_exp_f32 v208, v116
    v_exp_f32 v209, v117
    s_nop 0
    v_add_f32 v242, v242, v208
    v_add_f32 v242, v242, v209
    v_cvt_pk_bf16_f32 v202, v208, v209
    v_exp_f32 v208, v118
    v_exp_f32 v209, v119
    s_nop 0
    v_add_f32 v242, v242, v208
    v_add_f32 v242, v242, v209
    v_cvt_pk_bf16_f32 v203, v208, v209
    v_exp_f32 v208, v120
    v_exp_f32 v209, v121
    s_nop 0
    v_add_f32 v242, v242, v208
    v_add_f32 v242, v242, v209
    v_cvt_pk_bf16_f32 v204, v208, v209
    v_exp_f32 v208, v122
    v_exp_f32 v209, v123
    s_nop 0
    v_add_f32 v242, v242, v208
    v_add_f32 v242, v242, v209
    v_cvt_pk_bf16_f32 v205, v208, v209
    v_exp_f32 v208, v124
    v_exp_f32 v209, v125
    s_nop 0
    v_add_f32 v242, v242, v208
    v_add_f32 v242, v242, v209
    v_cvt_pk_bf16_f32 v206, v208, v209
    v_exp_f32 v208, v126
    v_exp_f32 v209, v127
    s_nop 0
    v_add_f32 v242, v242, v208
    v_add_f32 v242, v242, v209
    v_cvt_pk_bf16_f32 v207, v208, v209
    s_branch L_att3_back
L_loader:
    s_setprio 3
    s_mov_b32 s99, s98
    s_mov_b32 s84, s79
    s_mov_b32 s86, s80
    s_lshl_b32 s88, s32, 10
    s_add_u32 s88, s88, 512
    s_mul_i32 s78, s33, 98304
    s_mov_b32 s85, 114688
    s_mov_b32 s87, 65536
    s_and_b32 s80, s33, 0
    s_mov_b32 s79, 0
    s_barrier
    s_waitcnt vmcnt(0)
    s_mov_b32 s4, 0xfffe0000
    s_mov_b32 s5, 0xffffff
    s_mov_b32 s6, 0xffff
    s_mov_b32 s7, 0x0
    s_mov_b32 s8, 0x5555
    s_mov_b32 s9, 0x0
    s_mov_b32 s10, 0xffffffff
    s_mov_b32 s11, 0xffffff
    s_mov_b32 s12, 0x0
    s_mov_b32 s13, 0x0
    s_mov_b32 s14, 0xaaa8
    s_mov_b32 s15, 0x0
    s_mov_b32 s16, 0x40000
    s_mov_b32 s17, 0x0
    s_mov_b32 s18, 0x15554
    s_mov_b32 s19, 0x0
    s_mov_b32 s20, 0xfff80000
    s_mov_b32 s21, 0xffffff
    s_mov_b32 s22, 0x20000
    s_mov_b32 s23, 0x0
    s_mov_b32 s97, 65536
    s_mov_b32 s82, 0
    s_mov_b32 s89, 0
L_ld_loop:
    s_bitcmp1_b64 s[14:15], s82
    s_cbranch_scc1 L_ld_w44
    s_bitcmp1_b64 s[16:17], s82
    s_cbranch_scc1 L_ld_w40
    s_bitcmp1_b64 s[18:19], s82
    s_cbranch_scc1 L_ld_w32
    s_bitcmp1_b64 s[20:21], s82
    s_cbranch_scc1 L_ld_w24
    s_bitcmp1_b64 s[22:23], s82
    s_cbranch_scc1 L_ld_w16
    s_waitcnt vmcnt(63)
    s_branch L_ld_wd
L_ld_w44:
    s_waitcnt vmcnt(44)
    s_branch L_ld_wd
L_ld_w40:
    s_waitcnt vmcnt(40)
    s_branch L_ld_wd
L_ld_w32:
    s_waitcnt vmcnt(32)
    s_branch L_ld_wd
L_ld_w24:
    s_waitcnt vmcnt(24)
    s_branch L_ld_wd
L_ld_w16:
    s_waitcnt vmcnt(16)
L_ld_wd:
    s_barrier
    s_bitcmp1_b64 s[10:11], s82
    s_cbranch_scc0 L_ld_nokv1
    s_add_u32 m0, s96, 0
    s_add_u32 s100, s94, 0
    buffer_load_dwordx4 v23, s[40:43], s100 offen offset:0 nt lds
    buffer_load_dwordx4 v23, s[40:43], s100 offen offset:1024 nt lds
    buffer_load_dwordx4 v23, s[40:43], s100 offen offset:2048 nt lds
    buffer_load_dwordx4 v23, s[40:43], s100 offen offset:3072 nt lds
    s_add_u32 m0, s96, 4096
    s_add_u32 s100, s94, 4096
    buffer_load_dwordx4 v23, s[40:43], s100 offen offset:0 nt lds
    buffer_load_dwordx4 v23, s[40:43], s100 offen offset:1024 nt lds
    buffer_load_dwordx4 v23, s[40:43], s100 offen offset:2048 nt lds
    buffer_load_dwordx4 v23, s[40:43], s100 offen offset:3072 nt lds
    s_add_u32 s94, s94, 8192
    s_add_u32 s96, s96, 8192
    s_and_b32 s96, s96, 0x7fff
    s_or_b32 s96, s96, 32768
    s_add_u32 m0, s95, 0
    s_add_u32 s100, s83, 0
    buffer_load_dwordx4 v19, s[36:39], s100 offen offset:0 nt lds
    buffer_load_dwordx4 v20, s[36:39], s100 offen offset:1024 nt lds
    buffer_load_dwordx4 v21, s[36:39], s100 offen offset:2048 nt lds
    buffer_load_dwordx4 v22, s[36:39], s100 offen offset:3072 nt lds
    s_add_u32 m0, s95, 4096
    s_add_u32 s100, s83, 4096
    buffer_load_dwordx4 v19, s[36:39], s100 offen offset:0 nt lds
    buffer_load_dwordx4 v20, s[36:39], s100 offen offset:1024 nt lds
    buffer_load_dwordx4 v21, s[36:39], s100 offen offset:2048 nt lds
    buffer_load_dwordx4 v22, s[36:39], s100 offen offset:3072 nt lds
    s_add_u32 s83, s83, 8192
    s_add_u32 s95, s95, 8192
    s_and_b32 s95, s95, 0x7fff
    s_or_b32 s95, s95, 0
L_ld_nokv1:
    s_bitcmp1_b64 s[12:13], s82
    s_cbranch_scc0 L_ld_nokv2
    s_add_u32 m0, s96, 0
    s_add_u32 s100, s94, 0
    buffer_load_dwordx4 v23, s[40:43], s100 offen offset:0 nt lds
    buffer_load_dwordx4 v23, s[40:43], s100 offen offset:1024 nt lds
    buffer_load_dwordx4 v23, s[40:43], s100 offen offset:2048 nt lds
    buffer_load_dwordx4 v23, s[40:43], s100 offen offset:3072 nt lds
    s_add_u32 m0, s96, 4096
    s_add_u32 s100, s94, 4096
    buffer_load_dwordx4 v23, s[40:43], s100 offen offset:0 nt lds
    buffer_load_dwordx4 v23, s[40:43], s100 offen offset:1024 nt lds
    buffer_load_dwordx4 v23, s[40:43], s100 offen offset:2048 nt lds
    buffer_load_dwordx4 v23, s[40:43], s100 offen offset:3072 nt lds
    s_add_u32 s94, s94, 8192
    s_add_u32 s96, s96, 8192
    s_and_b32 s96, s96, 0x7fff
    s_or_b32 s96, s96, 32768
    s_add_u32 m0, s95, 0
    s_add_u32 s100, s83, 0
    buffer_load_dwordx4 v19, s[36:39], s100 offen offset:0 nt lds
    buffer_load_dwordx4 v20, s[36:39], s100 offen offset:1024 nt lds
    buffer_load_dwordx4 v21, s[36:39], s100 offen offset:2048 nt lds
    buffer_load_dwordx4 v22, s[36:39], s100 offen offset:3072 nt lds
    s_add_u32 m0, s95, 4096
    s_add_u32 s100, s83, 4096
    buffer_load_dwordx4 v19, s[36:39], s100 offen offset:0 nt lds
    buffer_load_dwordx4 v20, s[36:39], s100 offen offset:1024 nt lds
    buffer_load_dwordx4 v21, s[36:39], s100 offen offset:2048 nt lds
    buffer_load_dwordx4 v22, s[36:39], s100 offen offset:3072 nt lds
    s_add_u32 s83, s83, 8192
    s_add_u32 s95, s95, 8192
    s_and_b32 s95, s95, 0x7fff
    s_or_b32 s95, s95, 0
L_ld_nokv2:
    s_bitcmp1_b64 s[8:9], s82
    s_cbranch_scc0 L_ld_nox
    s_mov_b32 m0, s87
    s_add_u32 s100, s86, s78
    buffer_load_dwordx4 v17, s[48:51], s100 offen lds
    s_add_u32 m0, m0, s81
    s_add_u32 s100, s100, 8192
    buffer_load_dwordx4 v18, s[48:51], s100 offen lds
    s_add_u32 m0, m0, s81
    s_add_u32 s100, s100, 8192
    buffer_load_dwordx4 v17, s[48:51], s100 offen lds
    s_add_u32 m0, m0, s81
    s_add_u32 s100, s100, 8192
    buffer_load_dwordx4 v18, s[48:51], s100 offen lds
    s_add_u32 m0, m0, s81
    s_add_u32 s100, s100, 8192
    buffer_load_dwordx4 v17, s[48:51], s100 offen lds
    s_add_u32 m0, m0, s81
    s_add_u32 s100, s100, 8192
    buffer_load_dwordx4 v18, s[48:51], s100 offen lds
    s_add_u32 m0, m0, s81
    s_add_u32 s100, s100, 8192
    buffer_load_dwordx4 v17, s[48:51], s100 offen lds
    s_add_u32 m0, m0, s81
    s_add_u32 s100, s100, 8192
    buffer_load_dwordx4 v18, s[48:51], s100 offen lds
    s_add_u32 m0, m0, s81
    s_add_u32 s100, s100, 8192
    buffer_load_dwordx4 v17, s[48:51], s100 offen lds
    s_add_u32 m0, m0, s81
    s_add_u32 s100, s100, 8192
    buffer_load_dwordx4 v18, s[48:51], s100 offen lds
    s_add_u32 m0, m0, s81
    s_add_u32 s100, s100, 8192
    buffer_load_dwordx4 v17, s[48:51], s100 offen lds
    s_add_u32 m0, m0, s81
    s_add_u32 s100, s100, 8192
    buffer_load_dwordx4 v18, s[48:51], s100 offen lds
    s_add_u32 s86, s86, 128
    s_and_b32 s86, s86, 1023
    s_add_u32 s87, s87, 12288
    s_cmp_ge_u32 s87, 90112
    s_cselect_b32 s87, 65536, s87
L_ld_nox:
    s_bitcmp1_b64 s[6:7], s82
    s_cbranch_scc0 L_ld_nowq
    s_mov_b32 m0, s85
    s_add_u32 s100, s84, s88
    buffer_load_dwordx4 v16, s[44:47], s100 offen lds
    s_add_u32 m0, m0, s81
    s_add_u32 s100, s100, 32768
    buffer_load_dwordx4 v16, s[44:47], s100 offen lds
    s_add_u32 m0, m0, s81
    s_add_u32 s100, s100, 32768
    buffer_load_dwordx4 v16, s[44:47], s100 offen lds
    s_add_u32 m0, m0, s81
    s_add_u32 s100, s100, 32768
    buffer_load_dwordx4 v16, s[44:47], s100 offen lds
    s_add_u32 m0, m0, s81
    s_add_u32 s100, s100, 32768
    buffer_load_dwordx4 v16, s[44:47], s100 offen lds
    s_add_u32 m0, m0, s81
    s_add_u32 s100, s100, 32768
    buffer_load_dwordx4 v16, s[44:47], s100 offen lds
    s_add_u32 m0, m0, s81
    s_add_u32 s100, s100, 32768
    buffer_load_dwordx4 v16, s[44:47], s100 offen lds
    s_add_u32 m0, m0, s81
    s_add_u32 s100, s100, 32768
    buffer_load_dwordx4 v16, s[44:47], s100 offen lds
    s_add_u32 m0, m0, s81
    s_add_u32 s100, s84, s88
    s_add_u32 s100, s100, 256
    buffer_load_dwordx4 v16, s[44:47], s100 offen lds
    s_add_u32 m0, m0, s81
    s_add_u32 s100, s100, 32768
    buffer_load_dwordx4 v16, s[44:47], s100 offen lds
    s_add_u32 m0, m0, s81
    s_add_u32 s100, s100, 32768
    buffer_load_dwordx4 v16, s[44:47], s100 offen lds
    s_add_u32 m0, m0, s81
    s_add_u32 s100, s100, 32768
    buffer_load_dwordx4 v16, s[44:47], s100 offen lds
    s_add_u32 m0, m0, s81
    s_add_u32 s100, s100, 32768
    buffer_load_dwordx4 v16, s[44:47], s100 offen lds
    s_add_u32 m0, m0, s81
    s_add_u32 s100, s100, 32768
    buffer_load_dwordx4 v16, s[44:47], s100 offen lds
    s_add_u32 m0, m0, s81
    s_add_u32 s100, s100, 32768
    buffer_load_dwordx4 v16, s[44:47], s100 offen lds
    s_add_u32 m0, m0, s81
    s_add_u32 s100, s100, 32768
    buffer_load_dwordx4 v16, s[44:47], s100 offen lds
    s_add_u32 s84, s84, 262144
    s_and_b32 s84, s84, 4194303
    s_add_u32 s85, s85, 16384
    s_cmp_ge_u32 s85, 163840
    s_cselect_b32 s85, 114688, s85
L_ld_nowq:
    s_bitcmp1_b64 s[4:5], s82
    s_cbranch_scc0 L_ld_nowo
    s_mov_b32 m0, s97
    s_add_u32 s101, s79, s80
    s_and_b32 s101, s101, 7
    s_lshl_b32 s101, s101, 14
    s_add_u32 s101, s101, s98
    s_add_u32 s101, s101, s89
    s_add_u32 s100, s101, 0
    buffer_load_dwordx4 v200, s[52:55], s100 offen lds
    s_add_u32 m0, m0, s81
    s_add_u32 s100, s101, 8192
    buffer_load_dwordx4 v200, s[52:55], s100 offen lds
    s_add_u32 m0, m0, s81
    s_add_u32 s100, s101, 256
    buffer_load_dwordx4 v200, s[52:55], s100 offen lds
    s_add_u32 m0, m0, s81
    s_add_u32 s100, s101, 8448
    buffer_load_dwordx4 v200, s[52:55], s100 offen lds
    s_add_u32 m0, m0, s81
    s_add_u32 s100, s101, 512
    buffer_load_dwordx4 v200, s[52:55], s100 offen lds
    s_add_u32 m0, m0, s81
    s_add_u32 s100, s101, 8704
    buffer_load_dwordx4 v200, s[52:55], s100 offen lds
    s_add_u32 m0, m0, s81
    s_add_u32 s100, s101, 768
    buffer_load_dwordx4 v200, s[52:55], s100 offen lds
    s_add_u32 m0, m0, s81
    s_add_u32 s100, s101, 8960
    buffer_load_dwordx4 v200, s[52:55], s100 offen lds
    s_add_u32 s97, s97, 8192
    s_cmp_ge_u32 s97, 90112
    s_cselect_b32 s97, 65536, s97
    s_xor_b32 s89, s89, 128
    s_cmp_eq_u32 s89, 0
    s_cselect_b32 s101, 1, 0
    s_add_u32 s79, s79, s101
    s_cmp_eq_u32 s79, 8
    s_cselect_b32 s101, 131072, 0
    s_add_u32 s98, s98, s101
    s_and_b32 s79, s79, 7
L_ld_nowo:
    s_add_u32 s82, s82, 1
    s_cmp_lt_u32 s82, 56
    s_cbranch_scc1 L_ld_loop
    s_waitcnt vmcnt(24)
    s_barrier
    s_add_u32 m0, s96, 0
    s_add_u32 s100, s94, 0
    buffer_load_dwordx4 v23, s[40:43], s100 offen offset:0 nt lds
    buffer_load_dwordx4 v23, s[40:43], s100 offen offset:1024 nt lds
    buffer_load_dwordx4 v23, s[40:43], s100 offen offset:2048 nt lds
    buffer_load_dwordx4 v23, s[40:43], s100 offen offset:3072 nt lds
    s_add_u32 m0, s96, 4096
    s_add_u32 s100, s94, 4096
    buffer_load_dwordx4 v23, s[40:43], s100 offen offset:0 nt lds
    buffer_load_dwordx4 v23, s[40:43], s100 offen offset:1024 nt lds
    buffer_load_dwordx4 v23, s[40:43], s100 offen offset:2048 nt lds
    buffer_load_dwordx4 v23, s[40:43], s100 offen offset:3072 nt lds
    s_add_u32 s94, s94, 8192
    s_add_u32 s96, s96, 8192
    s_and_b32 s96, s96, 0x7fff
    s_or_b32 s96, s96, 32768
    s_add_u32 m0, s95, 0
    s_add_u32 s100, s83, 0
    buffer_load_dwordx4 v19, s[36:39], s100 offen offset:0 nt lds
    buffer_load_dwordx4 v20, s[36:39], s100 offen offset:1024 nt lds
    buffer_load_dwordx4 v21, s[36:39], s100 offen offset:2048 nt lds
    buffer_load_dwordx4 v22, s[36:39], s100 offen offset:3072 nt lds
    s_add_u32 m0, s95, 4096
    s_add_u32 s100, s83, 4096
    buffer_load_dwordx4 v19, s[36:39], s100 offen offset:0 nt lds
    buffer_load_dwordx4 v20, s[36:39], s100 offen offset:1024 nt lds
    buffer_load_dwordx4 v21, s[36:39], s100 offen offset:2048 nt lds
    buffer_load_dwordx4 v22, s[36:39], s100 offen offset:3072 nt lds
    s_add_u32 s83, s83, 8192
    s_add_u32 s95, s95, 8192
    s_and_b32 s95, s95, 0x7fff
    s_or_b32 s95, s95, 0
    s_mov_b32 m0, 65536
    s_add_u32 s101, s80, 3
    s_and_b32 s101, s101, 7
    s_lshl_b32 s101, s101, 14
    s_add_u32 s101, s101, s99
    s_add_u32 s101, s101, 262272
    s_add_u32 s100, s101, 0
    buffer_load_dwordx4 v200, s[52:55], s100 offen lds
    s_add_u32 m0, m0, s81
    s_add_u32 s100, s101, 8192
    buffer_load_dwordx4 v200, s[52:55], s100 offen lds
    s_add_u32 m0, m0, s81
    s_add_u32 s100, s101, 256
    buffer_load_dwordx4 v200, s[52:55], s100 offen lds
    s_add_u32 m0, m0, s81
    s_add_u32 s100, s101, 8448
    buffer_load_dwordx4 v200, s[52:55], s100 offen lds
    s_add_u32 m0, m0, s81
    s_add_u32 s100, s101, 512
    buffer_load_dwordx4 v200, s[52:55], s100 offen lds
    s_add_u32 m0, m0, s81
    s_add_u32 s100, s101, 8704
    buffer_load_dwordx4 v200, s[52:55], s100 offen lds
    s_add_u32 m0, m0, s81
    s_add_u32 s100, s101, 768
    buffer_load_dwordx4 v200, s[52:55], s100 offen lds
    s_add_u32 m0, m0, s81
    s_add_u32 s100, s101, 8960
    buffer_load_dwordx4 v200, s[52:55], s100 offen lds
    s_mov_b32 m0, 122880
    s_add_u32 s101, s80, 0
    s_and_b32 s101, s101, 7
    s_lshl_b32 s101, s101, 14
    s_add_u32 s101, s101, s99
    s_add_u32 s101, s101, 393216
    s_add_u32 s100, s101, 0
    buffer_load_dwordx4 v200, s[52:55], s100 offen lds
    s_add_u32 m0, m0, s81
    s_add_u32 s100, s101, 8192
    buffer_load_dwordx4 v200, s[52:55], s100 offen lds
    s_add_u32 m0, m0, s81
    s_add_u32 s100, s101, 256
    buffer_load_dwordx4 v200, s[52:55], s100 offen lds
    s_add_u32 m0, m0, s81
    s_add_u32 s100, s101, 8448
    buffer_load_dwordx4 v200, s[52:55], s100 offen lds
    s_add_u32 m0, m0, s81
    s_add_u32 s100, s101, 512
    buffer_load_dwordx4 v200, s[52:55], s100 offen lds
    s_add_u32 m0, m0, s81
    s_add_u32 s100, s101, 8704
    buffer_load_dwordx4 v200, s[52:55], s100 offen lds
    s_add_u32 m0, m0, s81
    s_add_u32 s100, s101, 768
    buffer_load_dwordx4 v200, s[52:55], s100 offen lds
    s_add_u32 m0, m0, s81
    s_add_u32 s100, s101, 8960
    buffer_load_dwordx4 v200, s[52:55], s100 offen lds
    s_mov_b32 m0, 131072
    s_add_u32 s101, s80, 1
    s_and_b32 s101, s101, 7
    s_lshl_b32 s101, s101, 14
    s_add_u32 s101, s101, s99
    s_add_u32 s101, s101, 393216
    s_add_u32 s100, s101, 0
    buffer_load_dwordx4 v200, s[52:55], s100 offen lds
    s_add_u32 m0, m0, s81
    s_add_u32 s100, s101, 8192
    buffer_load_dwordx4 v200, s[52:55], s100 offen lds
    s_add_u32 m0, m0, s81
    s_add_u32 s100, s101, 256
    buffer_load_dwordx4 v200, s[52:55], s100 offen lds
    s_add_u32 m0, m0, s81
    s_add_u32 s100, s101, 8448
    buffer_load_dwordx4 v200, s[52:55], s100 offen lds
    s_add_u32 m0, m0, s81
    s_add_u32 s100, s101, 512
    buffer_load_dwordx4 v200, s[52:55], s100 offen lds
    s_add_u32 m0, m0, s81
    s_add_u32 s100, s101, 8704
    buffer_load_dwordx4 v200, s[52:55], s100 offen lds
    s_add_u32 m0, m0, s81
    s_add_u32 s100, s101, 768
    buffer_load_dwordx4 v200, s[52:55], s100 offen lds
    s_add_u32 m0, m0, s81
    s_add_u32 s100, s101, 8960
    buffer_load_dwordx4 v200, s[52:55], s100 offen lds
    s_waitcnt vmcnt(40)
    s_barrier
    s_add_u32 m0, s96, 0
    s_add_u32 s100, s94, 0
    buffer_load_dwordx4 v23, s[40:43], s100 offen offset:0 nt lds
    buffer_load_dwordx4 v23, s[40:43], s100 offen offset:1024 nt lds
    buffer_load_dwordx4 v23, s[40:43], s100 offen offset:2048 nt lds
    buffer_load_dwordx4 v23, s[40:43], s100 offen offset:3072 nt lds
    s_add_u32 m0, s96, 4096
    s_add_u32 s100, s94, 4096
    buffer_load_dwordx4 v23, s[40:43], s100 offen offset:0 nt lds
    buffer_load_dwordx4 v23, s[40:43], s100 offen offset:1024 nt lds
    buffer_load_dwordx4 v23, s[40:43], s100 offen offset:2048 nt lds
    buffer_load_dwordx4 v23, s[40:43], s100 offen offset:3072 nt lds
    s_add_u32 s94, s94, 8192
    s_add_u32 s96, s96, 8192
    s_and_b32 s96, s96, 0x7fff
    s_or_b32 s96, s96, 32768
    s_add_u32 m0, s95, 0
    s_add_u32 s100, s83, 0
    buffer_load_dwordx4 v19, s[36:39], s100 offen offset:0 nt lds
    buffer_load_dwordx4 v20, s[36:39], s100 offen offset:1024 nt lds
    buffer_load_dwordx4 v21, s[36:39], s100 offen offset:2048 nt lds
    buffer_load_dwordx4 v22, s[36:39], s100 offen offset:3072 nt lds
    s_add_u32 m0, s95, 4096
    s_add_u32 s100, s83, 4096
    buffer_load_dwordx4 v19, s[36:39], s100 offen offset:0 nt lds
    buffer_load_dwordx4 v20, s[36:39], s100 offen offset:1024 nt lds
    buffer_load_dwordx4 v21, s[36:39], s100 offen offset:2048 nt lds
    buffer_load_dwordx4 v22, s[36:39], s100 offen offset:3072 nt lds
    s_add_u32 s83, s83, 8192
    s_add_u32 s95, s95, 8192
    s_and_b32 s95, s95, 0x7fff
    s_or_b32 s95, s95, 0
    s_mov_b32 m0, 73728
    s_add_u32 s101, s80, 4
    s_and_b32 s101, s101, 7
    s_lshl_b32 s101, s101, 14
    s_add_u32 s101, s101, s99
    s_add_u32 s101, s101, 262144
    s_add_u32 s100, s101, 0
    buffer_load_dwordx4 v200, s[52:55], s100 offen lds
    s_add_u32 m0, m0, s81
    s_add_u32 s100, s101, 8192
    buffer_load_dwordx4 v200, s[52:55], s100 offen lds
    s_add_u32 m0, m0, s81
    s_add_u32 s100, s101, 256
    buffer_load_dwordx4 v200, s[52:55], s100 offen lds
    s_add_u32 m0, m0, s81
    s_add_u32 s100, s101, 8448
    buffer_load_dwordx4 v200, s[52:55], s100 offen lds
    s_add_u32 m0, m0, s81
    s_add_u32 s100, s101, 512
    buffer_load_dwordx4 v200, s[52:55], s100 offen lds
    s_add_u32 m0, m0, s81
    s_add_u32 s100, s101, 8704
    buffer_load_dwordx4 v200, s[52:55], s100 offen lds
    s_add_u32 m0, m0, s81
    s_add_u32 s100, s101, 768
    buffer_load_dwordx4 v200, s[52:55], s100 offen lds
    s_add_u32 m0, m0, s81
    s_add_u32 s100, s101, 8960
    buffer_load_dwordx4 v200, s[52:55], s100 offen lds
    s_waitcnt vmcnt(40)
    s_barrier
    s_add_u32 m0, s96, 0
    s_add_u32 s100, s94, 0
    buffer_load_dwordx4 v23, s[40:43], s100 offen offset:0 nt lds
    buffer_load_dwordx4 v23, s[40:43], s100 offen offset:1024 nt lds
    buffer_load_dwordx4 v23, s[40:43], s100 offen offset:2048 nt lds
    buffer_load_dwordx4 v23, s[40:43], s100 offen offset:3072 nt lds
    s_add_u32 m0, s96, 4096
    s_add_u32 s100, s94, 4096
    buffer_load_dwordx4 v23, s[40:43], s100 offen offset:0 nt lds
    buffer_load_dwordx4 v23, s[40:43], s100 offen offset:1024 nt lds
    buffer_load_dwordx4 v23, s[40:43], s100 offen offset:2048 nt lds
    buffer_load_dwordx4 v23, s[40:43], s100 offen offset:3072 nt lds
    s_add_u32 s94, s94, 8192
    s_add_u32 s96, s96, 8192
    s_and_b32 s96, s96, 0x7fff
    s_or_b32 s96, s96, 32768
    s_add_u32 m0, s95, 0
    s_add_u32 s100, s83, 0
    buffer_load_dwordx4 v19, s[36:39], s100 offen offset:0 nt lds
    buffer_load_dwordx4 v20, s[36:39], s100 offen offset:1024 nt lds
    buffer_load_dwordx4 v21, s[36:39], s100 offen offset:2048 nt lds
    buffer_load_dwordx4 v22, s[36:39], s100 offen offset:3072 nt lds
    s_add_u32 m0, s95, 4096
    s_add_u32 s100, s83, 4096
    buffer_load_dwordx4 v19, s[36:39], s100 offen offset:0 nt lds
    buffer_load_dwordx4 v20, s[36:39], s100 offen offset:1024 nt lds
    buffer_load_dwordx4 v21, s[36:39], s100 offen offset:2048 nt lds
    buffer_load_dwordx4 v22, s[36:39], s100 offen offset:3072 nt lds
    s_add_u32 s83, s83, 8192
    s_add_u32 s95, s95, 8192
    s_and_b32 s95, s95, 0x7fff
    s_or_b32 s95, s95, 0
    s_mov_b32 m0, 81920
    s_add_u32 s101, s80, 4
    s_and_b32 s101, s101, 7
    s_lshl_b32 s101, s101, 14
    s_add_u32 s101, s101, s99
    s_add_u32 s101, s101, 262272
    s_add_u32 s100, s101, 0
    buffer_load_dwordx4 v200, s[52:55], s100 offen lds
    s_add_u32 m0, m0, s81
    s_add_u32 s100, s101, 8192
    buffer_load_dwordx4 v200, s[52:55], s100 offen lds
    s_add_u32 m0, m0, s81
    s_add_u32 s100, s101, 256
    buffer_load_dwordx4 v200, s[52:55], s100 offen lds
    s_add_u32 m0, m0, s81
    s_add_u32 s100, s101, 8448
    buffer_load_dwordx4 v200, s[52:55], s100 offen lds
    s_add_u32 m0, m0, s81
    s_add_u32 s100, s101, 512
    buffer_load_dwordx4 v200, s[52:55], s100 offen lds
    s_add_u32 m0, m0, s81
    s_add_u32 s100, s101, 8704
    buffer_load_dwordx4 v200, s[52:55], s100 offen lds
    s_add_u32 m0, m0, s81
    s_add_u32 s100, s101, 768
    buffer_load_dwordx4 v200, s[52:55], s100 offen lds
    s_add_u32 m0, m0, s81
    s_add_u32 s100, s101, 8960
    buffer_load_dwordx4 v200, s[52:55], s100 offen lds
    s_mov_b32 m0, 114688
    s_add_u32 s101, s80, 5
    s_and_b32 s101, s101, 7
    s_lshl_b32 s101, s101, 14
    s_add_u32 s101, s101, s99
    s_add_u32 s101, s101, 262272
    s_add_u32 s100, s101, 0
    buffer_load_dwordx4 v200, s[52:55], s100 offen lds
    s_add_u32 m0, m0, s81
    s_add_u32 s100, s101, 8192
    buffer_load_dwordx4 v200, s[52:55], s100 offen lds
    s_add_u32 m0, m0, s81
    s_add_u32 s100, s101, 256
    buffer_load_dwordx4 v200, s[52:55], s100 offen lds
    s_add_u32 m0, m0, s81
    s_add_u32 s100, s101, 8448
    buffer_load_dwordx4 v200, s[52:55], s100 offen lds
    s_add_u32 m0, m0, s81
    s_add_u32 s100, s101, 512
    buffer_load_dwordx4 v200, s[52:55], s100 offen lds
    s_add_u32 m0, m0, s81
    s_add_u32 s100, s101, 8704
    buffer_load_dwordx4 v200, s[52:55], s100 offen lds
    s_add_u32 m0, m0, s81
    s_add_u32 s100, s101, 768
    buffer_load_dwordx4 v200, s[52:55], s100 offen lds
    s_add_u32 m0, m0, s81
    s_add_u32 s100, s101, 8960
    buffer_load_dwordx4 v200, s[52:55], s100 offen lds
    s_waitcnt vmcnt(32)
    s_barrier
    s_add_u32 m0, s96, 0
    s_add_u32 s100, s94, 0
    buffer_load_dwordx4 v23, s[40:43], s100 offen offset:0 nt lds
    buffer_load_dwordx4 v23, s[40:43], s100 offen offset:1024 nt lds
    buffer_load_dwordx4 v23, s[40:43], s100 offen offset:2048 nt lds
    buffer_load_dwordx4 v23, s[40:43], s100 offen offset:3072 nt lds
    s_add_u32 m0, s96, 4096
    s_add_u32 s100, s94, 4096
    buffer_load_dwordx4 v23, s[40:43], s100 offen offset:0 nt lds
    buffer_load_dwordx4 v23, s[40:43], s100 offen offset:1024 nt lds
    buffer_load_dwordx4 v23, s[40:43], s100 offen offset:2048 nt lds
    buffer_load_dwordx4 v23, s[40:43], s100 offen offset:3072 nt lds
    s_add_u32 s94, s94, 8192
    s_add_u32 s96, s96, 8192
    s_and_b32 s96, s96, 0x7fff
    s_or_b32 s96, s96, 32768
    s_add_u32 m0, s95, 0
    s_add_u32 s100, s83, 0
    buffer_load_dwordx4 v19, s[36:39], s100 offen offset:0 nt lds
    buffer_load_dwordx4 v20, s[36:39], s100 offen offset:1024 nt lds
    buffer_load_dwordx4 v21, s[36:39], s100 offen offset:2048 nt lds
    buffer_load_dwordx4 v22, s[36:39], s100 offen offset:3072 nt lds
    s_add_u32 m0, s95, 4096
    s_add_u32 s100, s83, 4096
    buffer_load_dwordx4 v19, s[36:39], s100 offen offset:0 nt lds
    buffer_load_dwordx4 v20, s[36:39], s100 offen offset:1024 nt lds
    buffer_load_dwordx4 v21, s[36:39], s100 offen offset:2048 nt lds
    buffer_load_dwordx4 v22, s[36:39], s100 offen offset:3072 nt lds
    s_add_u32 s83, s83, 8192
    s_add_u32 s95, s95, 8192
    s_and_b32 s95, s95, 0x7fff
    s_or_b32 s95, s95, 0
    s_mov_b32 m0, 65536
    s_add_u32 s101, s80, 5
    s_and_b32 s101, s101, 7
    s_lshl_b32 s101, s101, 14
    s_add_u32 s101, s101, s99
    s_add_u32 s101, s101, 262144
    s_add_u32 s100, s101, 0
    buffer_load_dwordx4 v200, s[52:55], s100 offen lds
    s_add_u32 m0, m0, s81
    s_add_u32 s100, s101, 8192
    buffer_load_dwordx4 v200, s[52:55], s100 offen lds
    s_add_u32 m0, m0, s81
    s_add_u32 s100, s101, 256
    buffer_load_dwordx4 v200, s[52:55], s100 offen lds
    s_add_u32 m0, m0, s81
    s_add_u32 s100, s101, 8448
    buffer_load_dwordx4 v200, s[52:55], s100 offen lds
    s_add_u32 m0, m0, s81
    s_add_u32 s100, s101, 512
    buffer_load_dwordx4 v200, s[52:55], s100 offen lds
    s_add_u32 m0, m0, s81
    s_add_u32 s100, s101, 8704
    buffer_load_dwordx4 v200, s[52:55], s100 offen lds
    s_add_u32 m0, m0, s81
    s_add_u32 s100, s101, 768
    buffer_load_dwordx4 v200, s[52:55], s100 offen lds
    s_add_u32 m0, m0, s81
    s_add_u32 s100, s101, 8960
    buffer_load_dwordx4 v200, s[52:55], s100 offen lds
    s_waitcnt vmcnt(32)
    s_barrier
    s_add_u32 m0, s96, 0
    s_add_u32 s100, s94, 0
    buffer_load_dwordx4 v23, s[40:43], s100 offen offset:0 nt lds
    buffer_load_dwordx4 v23, s[40:43], s100 offen offset:1024 nt lds
    buffer_load_dwordx4 v23, s[40:43], s100 offen offset:2048 nt lds
    buffer_load_dwordx4 v23, s[40:43], s100 offen offset:3072 nt lds
    s_add_u32 m0, s96, 4096
    s_add_u32 s100, s94, 4096
    buffer_load_dwordx4 v23, s[40:43], s100 offen offset:0 nt lds
    buffer_load_dwordx4 v23, s[40:43], s100 offen offset:1024 nt lds
    buffer_load_dwordx4 v23, s[40:43], s100 offen offset:2048 nt lds
    buffer_load_dwordx4 v23, s[40:43], s100 offen offset:3072 nt lds
    s_add_u32 s94, s94, 8192
    s_add_u32 s96, s96, 8192
    s_and_b32 s96, s96, 0x7fff
    s_or_b32 s96, s96, 32768
    s_mov_b32 m0, 73728
    s_add_u32 s101, s80, 6
    s_and_b32 s101, s101, 7
    s_lshl_b32 s101, s101, 14
    s_add_u32 s101, s101, s99
    s_add_u32 s101, s101, 262144
    s_add_u32 s100, s101, 0
    buffer_load_dwordx4 v200, s[52:55], s100 offen lds
    s_add_u32 m0, m0, s81
    s_add_u32 s100, s101, 8192
    buffer_load_dwordx4 v200, s[52:55], s100 offen lds
    s_add_u32 m0, m0, s81
    s_add_u32 s100, s101, 256
    buffer_load_dwordx4 v200, s[52:55], s100 offen lds
    s_add_u32 m0, m0, s81
    s_add_u32 s100, s101, 8448
    buffer_load_dwordx4 v200, s[52:55], s100 offen lds
    s_add_u32 m0, m0, s81
    s_add_u32 s100, s101, 512
    buffer_load_dwordx4 v200, s[52:55], s100 offen lds
    s_add_u32 m0, m0, s81
    s_add_u32 s100, s101, 8704
    buffer_load_dwordx4 v200, s[52:55], s100 offen lds
    s_add_u32 m0, m0, s81
    s_add_u32 s100, s101, 768
    buffer_load_dwordx4 v200, s[52:55], s100 offen lds
    s_add_u32 m0, m0, s81
    s_add_u32 s100, s101, 8960
    buffer_load_dwordx4 v200, s[52:55], s100 offen lds
    s_mov_b32 m0, 0
    s_add_u32 s101, s80, 6
    s_and_b32 s101, s101, 7
    s_lshl_b32 s101, s101, 14
    s_add_u32 s101, s101, s99
    s_add_u32 s101, s101, 262272
    s_add_u32 s100, s101, 0
    buffer_load_dwordx4 v200, s[52:55], s100 offen lds
    s_add_u32 m0, m0, s81
    s_add_u32 s100, s101, 8192
    buffer_load_dwordx4 v200, s[52:55], s100 offen lds
    s_add_u32 m0, m0, s81
    s_add_u32 s100, s101, 256
    buffer_load_dwordx4 v200, s[52:55], s100 offen lds
    s_add_u32 m0, m0, s81
    s_add_u32 s100, s101, 8448
    buffer_load_dwordx4 v200, s[52:55], s100 offen lds
    s_add_u32 m0, m0, s81
    s_add_u32 s100, s101, 512
    buffer_load_dwordx4 v200, s[52:55], s100 offen lds
    s_add_u32 m0, m0, s81
    s_add_u32 s100, s101, 8704
    buffer_load_dwordx4 v200, s[52:55], s100 offen lds
    s_add_u32 m0, m0, s81
    s_add_u32 s100, s101, 768
    buffer_load_dwordx4 v200, s[52:55], s100 offen lds
    s_add_u32 m0, m0, s81
    s_add_u32 s100, s101, 8960
    buffer_load_dwordx4 v200, s[52:55], s100 offen lds
    s_waitcnt vmcnt(24)
    s_barrier
    s_mov_b32 m0, 81920
    s_add_u32 s101, s80, 7
    s_and_b32 s101, s101, 7
    s_lshl_b32 s101, s101, 14
    s_add_u32 s101, s101, s99
    s_add_u32 s101, s101, 262144
    s_add_u32 s100, s101, 0
    buffer_load_dwordx4 v200, s[52:55], s100 offen lds
    s_add_u32 m0, m0, s81
    s_add_u32 s100, s101, 8192
    buffer_load_dwordx4 v200, s[52:55], s100 offen lds
    s_add_u32 m0, m0, s81
    s_add_u32 s100, s101, 256
    buffer_load_dwordx4 v200, s[52:55], s100 offen lds
    s_add_u32 m0, m0, s81
    s_add_u32 s100, s101, 8448
    buffer_load_dwordx4 v200, s[52:55], s100 offen lds
    s_add_u32 m0, m0, s81
    s_add_u32 s100, s101, 512
    buffer_load_dwordx4 v200, s[52:55], s100 offen lds
    s_add_u32 m0, m0, s81
    s_add_u32 s100, s101, 8704
    buffer_load_dwordx4 v200, s[52:55], s100 offen lds
    s_add_u32 m0, m0, s81
    s_add_u32 s100, s101, 768
    buffer_load_dwordx4 v200, s[52:55], s100 offen lds
    s_add_u32 m0, m0, s81
    s_add_u32 s100, s101, 8960
    buffer_load_dwordx4 v200, s[52:55], s100 offen lds
    s_mov_b32 m0, 8192
    s_add_u32 s101, s80, 7
    s_and_b32 s101, s101, 7
    s_lshl_b32 s101, s101, 14
    s_add_u32 s101, s101, s99
    s_add_u32 s101, s101, 262272
    s_add_u32 s100, s101, 0
    buffer_load_dwordx4 v200, s[52:55], s100 offen lds
    s_add_u32 m0, m0, s81
    s_add_u32 s100, s101, 8192
    buffer_load_dwordx4 v200, s[52:55], s100 offen lds
    s_add_u32 m0, m0, s81
    s_add_u32 s100, s101, 256
    buffer_load_dwordx4 v200, s[52:55], s100 offen lds
    s_add_u32 m0, m0, s81
    s_add_u32 s100, s101, 8448
    buffer_load_dwordx4 v200, s[52:55], s100 offen lds
    s_add_u32 m0, m0, s81
    s_add_u32 s100, s101, 512
    buffer_load_dwordx4 v200, s[52:55], s100 offen lds
    s_add_u32 m0, m0, s81
    s_add_u32 s100, s101, 8704
    buffer_load_dwordx4 v200, s[52:55], s100 offen lds
    s_add_u32 m0, m0, s81
    s_add_u32 s100, s101, 768
    buffer_load_dwordx4 v200, s[52:55], s100 offen lds
    s_add_u32 m0, m0, s81
    s_add_u32 s100, s101, 8960
    buffer_load_dwordx4 v200, s[52:55], s100 offen lds
    s_mov_b32 m0, 32768
    s_add_u32 s101, s80, 2
    s_and_b32 s101, s101, 7
    s_lshl_b32 s101, s101, 14
    s_add_u32 s101, s101, s99
    s_add_u32 s101, s101, 393216
    s_add_u32 s100, s101, 0
    buffer_load_dwordx4 v200, s[52:55], s100 offen lds
    s_add_u32 m0, m0, s81
    s_add_u32 s100, s101, 8192
    buffer_load_dwordx4 v200, s[52:55], s100 offen lds
    s_add_u32 m0, m0, s81
    s_add_u32 s100, s101, 256
    buffer_load_dwordx4 v200, s[52:55], s100 offen lds
    s_add_u32 m0, m0, s81
    s_add_u32 s100, s101, 8448
    buffer_load_dwordx4 v200, s[52:55], s100 offen lds
    s_add_u32 m0, m0, s81
    s_add_u32 s100, s101, 512
    buffer_load_dwordx4 v200, s[52:55], s100 offen lds
    s_add_u32 m0, m0, s81
    s_add_u32 s100, s101, 8704
    buffer_load_dwordx4 v200, s[52:55], s100 offen lds
    s_add_u32 m0, m0, s81
    s_add_u32 s100, s101, 768
    buffer_load_dwordx4 v200, s[52:55], s100 offen lds
    s_add_u32 m0, m0, s81
    s_add_u32 s100, s101, 8960
    buffer_load_dwordx4 v200, s[52:55], s100 offen lds
    s_waitcnt vmcnt(24)
    s_barrier
    s_mov_b32 m0, 65536
    s_add_u32 s101, s80, 3
    s_and_b32 s101, s101, 7
    s_lshl_b32 s101, s101, 14
    s_add_u32 s101, s101, s99
    s_add_u32 s101, s101, 393216
    s_add_u32 s100, s101, 0
    buffer_load_dwordx4 v200, s[52:55], s100 offen lds
    s_add_u32 m0, m0, s81
    s_add_u32 s100, s101, 8192
    buffer_load_dwordx4 v200, s[52:55], s100 offen lds
    s_add_u32 m0, m0, s81
    s_add_u32 s100, s101, 256
    buffer_load_dwordx4 v200, s[52:55], s100 offen lds
    s_add_u32 m0, m0, s81
    s_add_u32 s100, s101, 8448
    buffer_load_dwordx4 v200, s[52:55], s100 offen lds
    s_add_u32 m0, m0, s81
    s_add_u32 s100, s101, 512
    buffer_load_dwordx4 v200, s[52:55], s100 offen lds
    s_add_u32 m0, m0, s81
    s_add_u32 s100, s101, 8704
    buffer_load_dwordx4 v200, s[52:55], s100 offen lds
    s_add_u32 m0, m0, s81
    s_add_u32 s100, s101, 768
    buffer_load_dwordx4 v200, s[52:55], s100 offen lds
    s_add_u32 m0, m0, s81
    s_add_u32 s100, s101, 8960
    buffer_load_dwordx4 v200, s[52:55], s100 offen lds
    s_mov_b32 m0, 114688
    s_add_u32 s101, s80, 4
    s_and_b32 s101, s101, 7
    s_lshl_b32 s101, s101, 14
    s_add_u32 s101, s101, s99
    s_add_u32 s101, s101, 393216
    s_add_u32 s100, s101, 0
    buffer_load_dwordx4 v200, s[52:55], s100 offen lds
    s_add_u32 m0, m0, s81
    s_add_u32 s100, s101, 8192
    buffer_load_dwordx4 v200, s[52:55], s100 offen lds
    s_add_u32 m0, m0, s81
    s_add_u32 s100, s101, 256
    buffer_load_dwordx4 v200, s[52:55], s100 offen lds
    s_add_u32 m0, m0, s81
    s_add_u32 s100, s101, 8448
    buffer_load_dwordx4 v200, s[52:55], s100 offen lds
    s_add_u32 m0, m0, s81
    s_add_u32 s100, s101, 512
    buffer_load_dwordx4 v200, s[52:55], s100 offen lds
    s_add_u32 m0, m0, s81
    s_add_u32 s100, s101, 8704
    buffer_load_dwordx4 v200, s[52:55], s100 offen lds
    s_add_u32 m0, m0, s81
    s_add_u32 s100, s101, 768
    buffer_load_dwordx4 v200, s[52:55], s100 offen lds
    s_add_u32 m0, m0, s81
    s_add_u32 s100, s101, 8960
    buffer_load_dwordx4 v200, s[52:55], s100 offen lds
    s_mov_b32 m0, 16384
    s_add_u32 s101, s80, 5
    s_and_b32 s101, s101, 7
    s_lshl_b32 s101, s101, 14
    s_add_u32 s101, s101, s99
    s_add_u32 s101, s101, 393216
    s_add_u32 s100, s101, 0
    buffer_load_dwordx4 v200, s[52:55], s100 offen lds
    s_add_u32 m0, m0, s81
    s_add_u32 s100, s101, 8192
    buffer_load_dwordx4 v200, s[52:55], s100 offen lds
    s_add_u32 m0, m0, s81
    s_add_u32 s100, s101, 256
    buffer_load_dwordx4 v200, s[52:55], s100 offen lds
    s_add_u32 m0, m0, s81
    s_add_u32 s100, s101, 8448
    buffer_load_dwordx4 v200, s[52:55], s100 offen lds
    s_add_u32 m0, m0, s81
    s_add_u32 s100, s101, 512
    buffer_load_dwordx4 v200, s[52:55], s100 offen lds
    s_add_u32 m0, m0, s81
    s_add_u32 s100, s101, 8704
    buffer_load_dwordx4 v200, s[52:55], s100 offen lds
    s_add_u32 m0, m0, s81
    s_add_u32 s100, s101, 768
    buffer_load_dwordx4 v200, s[52:55], s100 offen lds
    s_add_u32 m0, m0, s81
    s_add_u32 s100, s101, 8960
    buffer_load_dwordx4 v200, s[52:55], s100 offen lds
    s_mov_b32 m0, 40960
    s_add_u32 s101, s80, 6
    s_and_b32 s101, s101, 7
    s_lshl_b32 s101, s101, 14
    s_add_u32 s101, s101, s99
    s_add_u32 s101, s101, 393216
    s_add_u32 s100, s101, 0
    buffer_load_dwordx4 v200, s[52:55], s100 offen lds
    s_add_u32 m0, m0, s81
    s_add_u32 s100, s101, 8192
    buffer_load_dwordx4 v200, s[52:55], s100 offen lds
    s_add_u32 m0, m0, s81
    s_add_u32 s100, s101, 256
    buffer_load_dwordx4 v200, s[52:55], s100 offen lds
    s_add_u32 m0, m0, s81
    s_add_u32 s100, s101, 8448
    buffer_load_dwordx4 v200, s[52:55], s100 offen lds
    s_add_u32 m0, m0, s81
    s_add_u32 s100, s101, 512
    buffer_load_dwordx4 v200, s[52:55], s100 offen lds
    s_add_u32 m0, m0, s81
    s_add_u32 s100, s101, 8704
    buffer_load_dwordx4 v200, s[52:55], s100 offen lds
    s_add_u32 m0, m0, s81
    s_add_u32 s100, s101, 768
    buffer_load_dwordx4 v200, s[52:55], s100 offen lds
    s_add_u32 m0, m0, s81
    s_add_u32 s100, s101, 8960
    buffer_load_dwordx4 v200, s[52:55], s100 offen lds
    s_waitcnt vmcnt(40)
    s_barrier
    s_mov_b32 m0, 0
    s_add_u32 s101, s80, 0
    s_and_b32 s101, s101, 7
    s_lshl_b32 s101, s101, 14
    s_add_u32 s101, s101, s99
    s_add_u32 s101, s101, 393344
    s_add_u32 s100, s101, 0
    buffer_load_dwordx4 v200, s[52:55], s100 offen lds
    s_add_u32 m0, m0, s81
    s_add_u32 s100, s101, 8192
    buffer_load_dwordx4 v200, s[52:55], s100 offen lds
    s_add_u32 m0, m0, s81
    s_add_u32 s100, s101, 256
    buffer_load_dwordx4 v200, s[52:55], s100 offen lds
    s_add_u32 m0, m0, s81
    s_add_u32 s100, s101, 8448
    buffer_load_dwordx4 v200, s[52:55], s100 offen lds
    s_add_u32 m0, m0, s81
    s_add_u32 s100, s101, 512
    buffer_load_dwordx4 v200, s[52:55], s100 offen lds
    s_add_u32 m0, m0, s81
    s_add_u32 s100, s101, 8704
    buffer_load_dwordx4 v200, s[52:55], s100 offen lds
    s_add_u32 m0, m0, s81
    s_add_u32 s100, s101, 768
    buffer_load_dwordx4 v200, s[52:55], s100 offen lds
    s_add_u32 m0, m0, s81
    s_add_u32 s100, s101, 8960
    buffer_load_dwordx4 v200, s[52:55], s100 offen lds
    s_mov_b32 m0, 24576
    s_add_u32 s101, s80, 1
    s_and_b32 s101, s101, 7
    s_lshl_b32 s101, s101, 14
    s_add_u32 s101, s101, s99
    s_add_u32 s101, s101, 393344
    s_add_u32 s100, s101, 0
    buffer_load_dwordx4 v200, s[52:55], s100 offen lds
    s_add_u32 m0, m0, s81
    s_add_u32 s100, s101, 8192
    buffer_load_dwordx4 v200, s[52:55], s100 offen lds
    s_add_u32 m0, m0, s81
    s_add_u32 s100, s101, 256
    buffer_load_dwordx4 v200, s[52:55], s100 offen lds
    s_add_u32 m0, m0, s81
    s_add_u32 s100, s101, 8448
    buffer_load_dwordx4 v200, s[52:55], s100 offen lds
    s_add_u32 m0, m0, s81
    s_add_u32 s100, s101, 512
    buffer_load_dwordx4 v200, s[52:55], s100 offen lds
    s_add_u32 m0, m0, s81
    s_add_u32 s100, s101, 8704
    buffer_load_dwordx4 v200, s[52:55], s100 offen lds
    s_add_u32 m0, m0, s81
    s_add_u32 s100, s101, 768
    buffer_load_dwordx4 v200, s[52:55], s100 offen lds
    s_add_u32 m0, m0, s81
    s_add_u32 s100, s101, 8960
    buffer_load_dwordx4 v200, s[52:55], s100 offen lds
    s_mov_b32 m0, 49152
    s_add_u32 s101, s80, 2
    s_and_b32 s101, s101, 7
    s_lshl_b32 s101, s101, 14
    s_add_u32 s101, s101, s99
    s_add_u32 s101, s101, 393344
    s_add_u32 s100, s101, 0
    buffer_load_dwordx4 v200, s[52:55], s100 offen lds
    s_add_u32 m0, m0, s81
    s_add_u32 s100, s101, 8192
    buffer_load_dwordx4 v200, s[52:55], s100 offen lds
    s_add_u32 m0, m0, s81
    s_add_u32 s100, s101, 256
    buffer_load_dwordx4 v200, s[52:55], s100 offen lds
    s_add_u32 m0, m0, s81
    s_add_u32 s100, s101, 8448
    buffer_load_dwordx4 v200, s[52:55], s100 offen lds
    s_add_u32 m0, m0, s81
    s_add_u32 s100, s101, 512
    buffer_load_dwordx4 v200, s[52:55], s100 offen lds
    s_add_u32 m0, m0, s81
    s_add_u32 s100, s101, 8704
    buffer_load_dwordx4 v200, s[52:55], s100 offen lds
    s_add_u32 m0, m0, s81
    s_add_u32 s100, s101, 768
    buffer_load_dwordx4 v200, s[52:55], s100 offen lds
    s_add_u32 m0, m0, s81
    s_add_u32 s100, s101, 8960
    buffer_load_dwordx4 v200, s[52:55], s100 offen lds
    s_mov_b32 m0, 73728
    s_add_u32 s101, s80, 7
    s_and_b32 s101, s101, 7
    s_lshl_b32 s101, s101, 14
    s_add_u32 s101, s101, s99
    s_add_u32 s101, s101, 393216
    s_add_u32 s100, s101, 0
    buffer_load_dwordx4 v200, s[52:55], s100 offen lds
    s_add_u32 m0, m0, s81
    s_add_u32 s100, s101, 8192
    buffer_load_dwordx4 v200, s[52:55], s100 offen lds
    s_add_u32 m0, m0, s81
    s_add_u32 s100, s101, 256
    buffer_load_dwordx4 v200, s[52:55], s100 offen lds
    s_add_u32 m0, m0, s81
    s_add_u32 s100, s101, 8448
    buffer_load_dwordx4 v200, s[52:55], s100 offen lds
    s_add_u32 m0, m0, s81
    s_add_u32 s100, s101, 512
    buffer_load_dwordx4 v200, s[52:55], s100 offen lds
    s_add_u32 m0, m0, s81
    s_add_u32 s100, s101, 8704
    buffer_load_dwordx4 v200, s[52:55], s100 offen lds
    s_add_u32 m0, m0, s81
    s_add_u32 s100, s101, 768
    buffer_load_dwordx4 v200, s[52:55], s100 offen lds
    s_add_u32 m0, m0, s81
    s_add_u32 s100, s101, 8960
    buffer_load_dwordx4 v200, s[52:55], s100 offen lds
    s_waitcnt vmcnt(63)
    s_barrier
    s_mov_b32 m0, 81920
    s_add_u32 s101, s80, 3
    s_and_b32 s101, s101, 7
    s_lshl_b32 s101, s101, 14
    s_add_u32 s101, s101, s99
    s_add_u32 s101, s101, 393344
    s_add_u32 s100, s101, 0
    buffer_load_dwordx4 v200, s[52:55], s100 offen lds
    s_add_u32 m0, m0, s81
    s_add_u32 s100, s101, 8192
    buffer_load_dwordx4 v200, s[52:55], s100 offen lds
    s_add_u32 m0, m0, s81
    s_add_u32 s100, s101, 256
    buffer_load_dwordx4 v200, s[52:55], s100 offen lds
    s_add_u32 m0, m0, s81
    s_add_u32 s100, s101, 8448
    buffer_load_dwordx4 v200, s[52:55], s100 offen lds
    s_add_u32 m0, m0, s81
    s_add_u32 s100, s101, 512
    buffer_load_dwordx4 v200, s[52:55], s100 offen lds
    s_add_u32 m0, m0, s81
    s_add_u32 s100, s101, 8704
    buffer_load_dwordx4 v200, s[52:55], s100 offen lds
    s_add_u32 m0, m0, s81
    s_add_u32 s100, s101, 768
    buffer_load_dwordx4 v200, s[52:55], s100 offen lds
    s_add_u32 m0, m0, s81
    s_add_u32 s100, s101, 8960
    buffer_load_dwordx4 v200, s[52:55], s100 offen lds
    s_mov_b32 m0, 8192
    s_add_u32 s101, s80, 4
    s_and_b32 s101, s101, 7
    s_lshl_b32 s101, s101, 14
    s_add_u32 s101, s101, s99
    s_add_u32 s101, s101, 393344
    s_add_u32 s100, s101, 0
    buffer_load_dwordx4 v200, s[52:55], s100 offen lds
    s_add_u32 m0, m0, s81
    s_add_u32 s100, s101, 8192
    buffer_load_dwordx4 v200, s[52:55], s100 offen lds
    s_add_u32 m0, m0, s81
    s_add_u32 s100, s101, 256
    buffer_load_dwordx4 v200, s[52:55], s100 offen lds
    s_add_u32 m0, m0, s81
    s_add_u32 s100, s101, 8448
    buffer_load_dwordx4 v200, s[52:55], s100 offen lds
    s_add_u32 m0, m0, s81
    s_add_u32 s100, s101, 512
    buffer_load_dwordx4 v200, s[52:55], s100 offen lds
    s_add_u32 m0, m0, s81
    s_add_u32 s100, s101, 8704
    buffer_load_dwordx4 v200, s[52:55], s100 offen lds
    s_add_u32 m0, m0, s81
    s_add_u32 s100, s101, 768
    buffer_load_dwordx4 v200, s[52:55], s100 offen lds
    s_add_u32 m0, m0, s81
    s_add_u32 s100, s101, 8960
    buffer_load_dwordx4 v200, s[52:55], s100 offen lds
    s_mov_b32 m0, 57344
    s_add_u32 s101, s80, 5
    s_and_b32 s101, s101, 7
    s_lshl_b32 s101, s101, 14
    s_add_u32 s101, s101, s99
    s_add_u32 s101, s101, 393344
    s_add_u32 s100, s101, 0
    buffer_load_dwordx4 v200, s[52:55], s100 offen lds
    s_add_u32 m0, m0, s81
    s_add_u32 s100, s101, 8192
    buffer_load_dwordx4 v200, s[52:55], s100 offen lds
    s_add_u32 m0, m0, s81
    s_add_u32 s100, s101, 256
    buffer_load_dwordx4 v200, s[52:55], s100 offen lds
    s_add_u32 m0, m0, s81
    s_add_u32 s100, s101, 8448
    buffer_load_dwordx4 v200, s[52:55], s100 offen lds
    s_add_u32 m0, m0, s81
    s_add_u32 s100, s101, 512
    buffer_load_dwordx4 v200, s[52:55], s100 offen lds
    s_add_u32 m0, m0, s81
    s_add_u32 s100, s101, 8704
    buffer_load_dwordx4 v200, s[52:55], s100 offen lds
    s_add_u32 m0, m0, s81
    s_add_u32 s100, s101, 768
    buffer_load_dwordx4 v200, s[52:55], s100 offen lds
    s_add_u32 m0, m0, s81
    s_add_u32 s100, s101, 8960
    buffer_load_dwordx4 v200, s[52:55], s100 offen lds
    s_mov_b32 m0, 139264
    s_add_u32 s101, s80, 6
    s_and_b32 s101, s101, 7
    s_lshl_b32 s101, s101, 14
    s_add_u32 s101, s101, s99
    s_add_u32 s101, s101, 393344
    s_add_u32 s100, s101, 0
    buffer_load_dwordx4 v200, s[52:55], s100 offen lds
    s_add_u32 m0, m0, s81
    s_add_u32 s100, s101, 8192
    buffer_load_dwordx4 v200, s[52:55], s100 offen lds
    s_add_u32 m0, m0, s81
    s_add_u32 s100, s101, 256
    buffer_load_dwordx4 v200, s[52:55], s100 offen lds
    s_add_u32 m0, m0, s81
    s_add_u32 s100, s101, 8448
    buffer_load_dwordx4 v200, s[52:55], s100 offen lds
    s_add_u32 m0, m0, s81
    s_add_u32 s100, s101, 512
    buffer_load_dwordx4 v200, s[52:55], s100 offen lds
    s_add_u32 m0, m0, s81
    s_add_u32 s100, s101, 8704
    buffer_load_dwordx4 v200, s[52:55], s100 offen lds
    s_add_u32 m0, m0, s81
    s_add_u32 s100, s101, 768
    buffer_load_dwordx4 v200, s[52:55], s100 offen lds
    s_add_u32 m0, m0, s81
    s_add_u32 s100, s101, 8960
    buffer_load_dwordx4 v200, s[52:55], s100 offen lds
    s_mov_b32 m0, 147456
    s_add_u32 s101, s80, 7
    s_and_b32 s101, s101, 7
    s_lshl_b32 s101, s101, 14
    s_add_u32 s101, s101, s99
    s_add_u32 s101, s101, 393344
    s_add_u32 s100, s101, 0
    buffer_load_dwordx4 v200, s[52:55], s100 offen lds
    s_add_u32 m0, m0, s81
    s_add_u32 s100, s101, 8192
    buffer_load_dwordx4 v200, s[52:55], s100 offen lds
    s_add_u32 m0, m0, s81
    s_add_u32 s100, s101, 256
    buffer_load_dwordx4 v200, s[52:55], s100 offen lds
    s_add_u32 m0, m0, s81
    s_add_u32 s100, s101, 8448
    buffer_load_dwordx4 v200, s[52:55], s100 offen lds
    s_add_u32 m0, m0, s81
    s_add_u32 s100, s101, 512
    buffer_load_dwordx4 v200, s[52:55], s100 offen lds
    s_add_u32 m0, m0, s81
    s_add_u32 s100, s101, 8704
    buffer_load_dwordx4 v200, s[52:55], s100 offen lds
    s_add_u32 m0, m0, s81
    s_add_u32 s100, s101, 768
    buffer_load_dwordx4 v200, s[52:55], s100 offen lds
    s_add_u32 m0, m0, s81
    s_add_u32 s100, s101, 8960
    buffer_load_dwordx4 v200, s[52:55], s100 offen lds
    s_waitcnt vmcnt(40)
    s_barrier
    s_waitcnt vmcnt(0)
    s_barrier
    s_branch L_reduce
L_wproj:
    s_setprio 0
    s_and_b32 s75, s33, 0
    s_barrier
    s_barrier
    s_waitcnt vmcnt(0)
    s_barrier
    s_barrier
    ds_read_b64_tr_b16 v[96:97], v228 offset:0
    ds_read_b64_tr_b16 v[98:99], v228 offset:1024
    ds_read_b64_tr_b16 v[100:101], v228 offset:8192
    ds_read_b64_tr_b16 v[102:103], v228 offset:9216
    ds_read_b128 v[112:115], v229 offset:0
    ds_read_b128 v[116:119], v229 offset:4096
    ds_read_b128 v[120:123], v229 offset:8192
    ds_read_b64_tr_b16 v[104:105], v228 offset:4096
    ds_read_b64_tr_b16 v[106:107], v228 offset:5120
    ds_read_b64_tr_b16 v[108:109], v228 offset:12288
    ds_read_b64_tr_b16 v[110:111], v228 offset:13312
    ds_read_b128 v[124:127], v230 offset:0
    ds_read_b128 v[128:131], v230 offset:4096
    ds_read_b128 v[132:135], v230 offset:8192
    s_waitcnt lgkmcnt(9)
    v_mfma_f32_32x32x16_bf16 v[0:15], v[96:99], v[112:115], 0
    s_waitcnt lgkmcnt(8)
    v_mfma_f32_32x32x16_bf16 v[16:31], v[96:99], v[116:119], 0
    s_waitcnt lgkmcnt(7)
    v_mfma_f32_32x32x16_bf16 v[32:47], v[96:99], v[120:123], 0
    v_mfma_f32_32x32x16_bf16 v[48:63], v[100:103], v[112:115], 0
    v_mfma_f32_32x32x16_bf16 v[64:79], v[100:103], v[116:119], 0
    v_mfma_f32_32x32x16_bf16 v[80:95], v[100:103], v[120:123], 0
    s_waitcnt lgkmcnt(2)
    v_mfma_f32_32x32x16_bf16 v[0:15], v[104:107], v[124:127], v[0:15]
    s_waitcnt lgkmcnt(1)
    v_mfma_f32_32x32x16_bf16 v[16:31], v[104:107], v[128:131], v[16:31]
    s_waitcnt lgkmcnt(0)
    v_mfma_f32_32x32x16_bf16 v[32:47], v[104:107], v[132:135], v[32:47]
    v_mfma_f32_32x32x16_bf16 v[48:63], v[108:111], v[124:127], v[48:63]
    v_mfma_f32_32x32x16_bf16 v[64:79], v[108:111], v[128:131], v[64:79]
    v_mfma_f32_32x32x16_bf16 v[80:95], v[108:111], v[132:135], v[80:95]
    s_barrier
    ds_read_b64_tr_b16 v[96:97], v228 offset:16384
    ds_read_b64_tr_b16 v[98:99], v228 offset:17408
    ds_read_b64_tr_b16 v[100:101], v228 offset:24576
    ds_read_b64_tr_b16 v[102:103], v228 offset:25600
    ds_read_b128 v[112:115], v231 offset:0
    ds_read_b128 v[116:119], v231 offset:4096
    ds_read_b128 v[120:123], v231 offset:8192
    ds_read_b64_tr_b16 v[104:105], v228 offset:20480
    ds_read_b64_tr_b16 v[106:107], v228 offset:21504
    ds_read_b64_tr_b16 v[108:109], v228 offset:28672
    ds_read_b64_tr_b16 v[110:111], v228 offset:29696
    ds_read_b128 v[124:127], v232 offset:0
    ds_read_b128 v[128:131], v232 offset:4096
    ds_read_b128 v[132:135], v232 offset:8192
    s_waitcnt lgkmcnt(9)
    v_mfma_f32_32x32x16_bf16 v[0:15], v[96:99], v[112:115], v[0:15]
    s_waitcnt lgkmcnt(8)
    v_mfma_f32_32x32x16_bf16 v[16:31], v[96:99], v[116:119], v[16:31]
    s_waitcnt lgkmcnt(7)
    v_mfma_f32_32x32x16_bf16 v[32:47], v[96:99], v[120:123], v[32:47]
    v_mfma_f32_32x32x16_bf16 v[48:63], v[100:103], v[112:115], v[48:63]
    v_mfma_f32_32x32x16_bf16 v[64:79], v[100:103], v[116:119], v[64:79]
    v_mfma_f32_32x32x16_bf16 v[80:95], v[100:103], v[120:123], v[80:95]
    s_waitcnt lgkmcnt(2)
    v_mfma_f32_32x32x16_bf16 v[0:15], v[104:107], v[124:127], v[0:15]
    s_waitcnt lgkmcnt(1)
    v_mfma_f32_32x32x16_bf16 v[16:31], v[104:107], v[128:131], v[16:31]
    s_waitcnt lgkmcnt(0)
    v_mfma_f32_32x32x16_bf16 v[32:47], v[104:107], v[132:135], v[32:47]
    v_mfma_f32_32x32x16_bf16 v[48:63], v[108:111], v[124:127], v[48:63]
    v_mfma_f32_32x32x16_bf16 v[64:79], v[108:111], v[128:131], v[64:79]
    v_mfma_f32_32x32x16_bf16 v[80:95], v[108:111], v[132:135], v[80:95]
    s_barrier
    ds_read_b64_tr_b16 v[96:97], v228 offset:32768
    ds_read_b64_tr_b16 v[98:99], v228 offset:33792
    ds_read_b64_tr_b16 v[100:101], v228 offset:40960
    ds_read_b64_tr_b16 v[102:103], v228 offset:41984
    ds_read_b128 v[112:115], v229 offset:12288
    ds_read_b128 v[116:119], v229 offset:16384
    ds_read_b128 v[120:123], v229 offset:20480
    ds_read_b64_tr_b16 v[104:105], v228 offset:36864
    ds_read_b64_tr_b16 v[106:107], v228 offset:37888
    ds_read_b64_tr_b16 v[108:109], v228 offset:45056
    ds_read_b64_tr_b16 v[110:111], v228 offset:46080
    ds_read_b128 v[124:127], v230 offset:12288
    ds_read_b128 v[128:131], v230 offset:16384
    ds_read_b128 v[132:135], v230 offset:20480
    s_waitcnt lgkmcnt(9)
    v_mfma_f32_32x32x16_bf16 v[0:15], v[96:99], v[112:115], v[0:15]
    s_waitcnt lgkmcnt(8)
    v_mfma_f32_32x32x16_bf16 v[16:31], v[96:99], v[116:119], v[16:31]
    s_waitcnt lgkmcnt(7)
    v_mfma_f32_32x32x16_bf16 v[32:47], v[96:99], v[120:123], v[32:47]
    v_mfma_f32_32x32x16_bf16 v[48:63], v[100:103], v[112:115], v[48:63]
    v_mfma_f32_32x32x16_bf16 v[64:79], v[100:103], v[116:119], v[64:79]
    v_mfma_f32_32x32x16_bf16 v[80:95], v[100:103], v[120:123], v[80:95]
    s_waitcnt lgkmcnt(2)
    v_mfma_f32_32x32x16_bf16 v[0:15], v[104:107], v[124:127], v[0:15]
    s_waitcnt lgkmcnt(1)
    v_mfma_f32_32x32x16_bf16 v[16:31], v[104:107], v[128:131], v[16:31]
    s_waitcnt lgkmcnt(0)
    v_mfma_f32_32x32x16_bf16 v[32:47], v[104:107], v[132:135], v[32:47]
    v_mfma_f32_32x32x16_bf16 v[48:63], v[108:111], v[124:127], v[48:63]
    v_mfma_f32_32x32x16_bf16 v[64:79], v[108:111], v[128:131], v[64:79]
    v_mfma_f32_32x32x16_bf16 v[80:95], v[108:111], v[132:135], v[80:95]
    s_waitcnt vmcnt(0)
    s_barrier
    ds_read_b64_tr_b16 v[96:97], v228 offset:0
    ds_read_b64_tr_b16 v[98:99], v228 offset:1024
    ds_read_b64_tr_b16 v[100:101], v228 offset:8192
    ds_read_b64_tr_b16 v[102:103], v228 offset:9216
    ds_read_b128 v[112:115], v231 offset:12288
    ds_read_b128 v[116:119], v231 offset:16384
    ds_read_b128 v[120:123], v231 offset:20480
    ds_read_b64_tr_b16 v[104:105], v228 offset:4096
    ds_read_b64_tr_b16 v[106:107], v228 offset:5120
    ds_read_b64_tr_b16 v[108:109], v228 offset:12288
    ds_read_b64_tr_b16 v[110:111], v228 offset:13312
    ds_read_b128 v[124:127], v232 offset:12288
    ds_read_b128 v[128:131], v232 offset:16384
    ds_read_b128 v[132:135], v232 offset:20480
    s_waitcnt lgkmcnt(9)
    v_mfma_f32_32x32x16_bf16 v[0:15], v[96:99], v[112:115], v[0:15]
    s_waitcnt lgkmcnt(8)
    v_mfma_f32_32x32x16_bf16 v[16:31], v[96:99], v[116:119], v[16:31]
    s_waitcnt lgkmcnt(7)
    v_mfma_f32_32x32x16_bf16 v[32:47], v[96:99], v[120:123], v[32:47]
    v_mfma_f32_32x32x16_bf16 v[48:63], v[100:103], v[112:115], v[48:63]
    v_mfma_f32_32x32x16_bf16 v[64:79], v[100:103], v[116:119], v[64:79]
    v_mfma_f32_32x32x16_bf16 v[80:95], v[100:103], v[120:123], v[80:95]
    s_waitcnt lgkmcnt(2)
    v_mfma_f32_32x32x16_bf16 v[0:15], v[104:107], v[124:127], v[0:15]
    s_waitcnt lgkmcnt(1)
    v_mfma_f32_32x32x16_bf16 v[16:31], v[104:107], v[128:131], v[16:31]
    s_waitcnt lgkmcnt(0)
    v_mfma_f32_32x32x16_bf16 v[32:47], v[104:107], v[132:135], v[32:47]
    v_mfma_f32_32x32x16_bf16 v[48:63], v[108:111], v[124:127], v[48:63]
    v_mfma_f32_32x32x16_bf16 v[64:79], v[108:111], v[128:131], v[64:79]
    v_mfma_f32_32x32x16_bf16 v[80:95], v[108:111], v[132:135], v[80:95]
    s_barrier
    ds_read_b64_tr_b16 v[96:97], v228 offset:16384
    ds_read_b64_tr_b16 v[98:99], v228 offset:17408
    ds_read_b64_tr_b16 v[100:101], v228 offset:24576
    ds_read_b64_tr_b16 v[102:103], v228 offset:25600
    ds_read_b128 v[112:115], v229 offset:0
    ds_read_b128 v[116:119], v229 offset:4096
    ds_read_b128 v[120:123], v229 offset:8192
    ds_read_b64_tr_b16 v[104:105], v228 offset:20480
    ds_read_b64_tr_b16 v[106:107], v228 offset:21504
    ds_read_b64_tr_b16 v[108:109], v228 offset:28672
    ds_read_b64_tr_b16 v[110:111], v228 offset:29696
    ds_read_b128 v[124:127], v230 offset:0
    ds_read_b128 v[128:131], v230 offset:4096
    ds_read_b128 v[132:135], v230 offset:8192
    s_waitcnt lgkmcnt(9)
    v_mfma_f32_32x32x16_bf16 v[0:15], v[96:99], v[112:115], v[0:15]
    s_waitcnt lgkmcnt(8)
    v_mfma_f32_32x32x16_bf16 v[16:31], v[96:99], v[116:119], v[16:31]
    s_waitcnt lgkmcnt(7)
    v_mfma_f32_32x32x16_bf16 v[32:47], v[96:99], v[120:123], v[32:47]
    v_mfma_f32_32x32x16_bf16 v[48:63], v[100:103], v[112:115], v[48:63]
    v_mfma_f32_32x32x16_bf16 v[64:79], v[100:103], v[116:119], v[64:79]
    v_mfma_f32_32x32x16_bf16 v[80:95], v[100:103], v[120:123], v[80:95]
    s_waitcnt lgkmcnt(2)
    v_mfma_f32_32x32x16_bf16 v[0:15], v[104:107], v[124:127], v[0:15]
    s_waitcnt lgkmcnt(1)
    v_mfma_f32_32x32x16_bf16 v[16:31], v[104:107], v[128:131], v[16:31]
    s_waitcnt lgkmcnt(0)
    v_mfma_f32_32x32x16_bf16 v[32:47], v[104:107], v[132:135], v[32:47]
    v_mfma_f32_32x32x16_bf16 v[48:63], v[108:111], v[124:127], v[48:63]
    v_mfma_f32_32x32x16_bf16 v[64:79], v[108:111], v[128:131], v[64:79]
    v_mfma_f32_32x32x16_bf16 v[80:95], v[108:111], v[132:135], v[80:95]
    s_barrier
    ds_read_b64_tr_b16 v[96:97], v228 offset:32768
    ds_read_b64_tr_b16 v[98:99], v228 offset:33792
    ds_read_b64_tr_b16 v[100:101], v228 offset:40960
    ds_read_b64_tr_b16 v[102:103], v228 offset:41984
    ds_read_b128 v[112:115], v231 offset:0
    ds_read_b128 v[116:119], v231 offset:4096
    ds_read_b128 v[120:123], v231 offset:8192
    ds_read_b64_tr_b16 v[104:105], v228 offset:36864
    ds_read_b64_tr_b16 v[106:107], v228 offset:37888
    ds_read_b64_tr_b16 v[108:109], v228 offset:45056
    ds_read_b64_tr_b16 v[110:111], v228 offset:46080
    ds_read_b128 v[124:127], v232 offset:0
    ds_read_b128 v[128:131], v232 offset:4096
    ds_read_b128 v[132:135], v232 offset:8192
    s_waitcnt lgkmcnt(9)
    v_mfma_f32_32x32x16_bf16 v[0:15], v[96:99], v[112:115], v[0:15]
    s_waitcnt lgkmcnt(8)
    v_mfma_f32_32x32x16_bf16 v[16:31], v[96:99], v[116:119], v[16:31]
    s_waitcnt lgkmcnt(7)
    v_mfma_f32_32x32x16_bf16 v[32:47], v[96:99], v[120:123], v[32:47]
    v_mfma_f32_32x32x16_bf16 v[48:63], v[100:103], v[112:115], v[48:63]
    v_mfma_f32_32x32x16_bf16 v[64:79], v[100:103], v[116:119], v[64:79]
    v_mfma_f32_32x32x16_bf16 v[80:95], v[100:103], v[120:123], v[80:95]
    s_waitcnt lgkmcnt(2)
    v_mfma_f32_32x32x16_bf16 v[0:15], v[104:107], v[124:127], v[0:15]
    s_waitcnt lgkmcnt(1)
    v_mfma_f32_32x32x16_bf16 v[16:31], v[104:107], v[128:131], v[16:31]
    s_waitcnt lgkmcnt(0)
    v_mfma_f32_32x32x16_bf16 v[32:47], v[104:107], v[132:135], v[32:47]
    v_mfma_f32_32x32x16_bf16 v[48:63], v[108:111], v[124:127], v[48:63]
    v_mfma_f32_32x32x16_bf16 v[64:79], v[108:111], v[128:131], v[64:79]
    v_mfma_f32_32x32x16_bf16 v[80:95], v[108:111], v[132:135], v[80:95]
    s_barrier
    ds_read_b64_tr_b16 v[96:97], v228 offset:0
    ds_read_b64_tr_b16 v[98:99], v228 offset:1024
    ds_read_b64_tr_b16 v[100:101], v228 offset:8192
    ds_read_b64_tr_b16 v[102:103], v228 offset:9216
    ds_read_b128 v[112:115], v229 offset:12288
    ds_read_b128 v[116:119], v229 offset:16384
    ds_read_b128 v[120:123], v229 offset:20480
    ds_read_b64_tr_b16 v[104:105], v228 offset:4096
    ds_read_b64_tr_b16 v[106:107], v228 offset:5120
    ds_read_b64_tr_b16 v[108:109], v228 offset:12288
    ds_read_b64_tr_b16 v[110:111], v228 offset:13312
    ds_read_b128 v[124:127], v230 offset:12288
    ds_read_b128 v[128:131], v230 offset:16384
    ds_read_b128 v[132:135], v230 offset:20480
    s_waitcnt lgkmcnt(9)
    v_mfma_f32_32x32x16_bf16 v[0:15], v[96:99], v[112:115], v[0:15]
    s_waitcnt lgkmcnt(8)
    v_mfma_f32_32x32x16_bf16 v[16:31], v[96:99], v[116:119], v[16:31]
    s_waitcnt lgkmcnt(7)
    v_mfma_f32_32x32x16_bf16 v[32:47], v[96:99], v[120:123], v[32:47]
    v_mfma_f32_32x32x16_bf16 v[48:63], v[100:103], v[112:115], v[48:63]
    v_mfma_f32_32x32x16_bf16 v[64:79], v[100:103], v[116:119], v[64:79]
    v_mfma_f32_32x32x16_bf16 v[80:95], v[100:103], v[120:123], v[80:95]
    s_waitcnt lgkmcnt(2)
    v_mfma_f32_32x32x16_bf16 v[0:15], v[104:107], v[124:127], v[0:15]
    s_waitcnt lgkmcnt(1)
    v_mfma_f32_32x32x16_bf16 v[16:31], v[104:107], v[128:131], v[16:31]
    s_waitcnt lgkmcnt(0)
    v_mfma_f32_32x32x16_bf16 v[32:47], v[104:107], v[132:135], v[32:47]
    v_mfma_f32_32x32x16_bf16 v[48:63], v[108:111], v[124:127], v[48:63]
    v_mfma_f32_32x32x16_bf16 v[64:79], v[108:111], v[128:131], v[64:79]
    v_mfma_f32_32x32x16_bf16 v[80:95], v[108:111], v[132:135], v[80:95]
    s_barrier
    ds_read_b64_tr_b16 v[96:97], v228 offset:16384
    ds_read_b64_tr_b16 v[98:99], v228 offset:17408
    ds_read_b64_tr_b16 v[100:101], v228 offset:24576
    ds_read_b64_tr_b16 v[102:103], v228 offset:25600
    ds_read_b128 v[112:115], v231 offset:12288
    ds_read_b128 v[116:119], v231 offset:16384
    ds_read_b128 v[120:123], v231 offset:20480
    ds_read_b64_tr_b16 v[104:105], v228 offset:20480
    ds_read_b64_tr_b16 v[106:107], v228 offset:21504
    ds_read_b64_tr_b16 v[108:109], v228 offset:28672
    ds_read_b64_tr_b16 v[110:111], v228 offset:29696
    ds_read_b128 v[124:127], v232 offset:12288
    ds_read_b128 v[128:131], v232 offset:16384
    ds_read_b128 v[132:135], v232 offset:20480
    s_waitcnt lgkmcnt(9)
    v_mfma_f32_32x32x16_bf16 v[0:15], v[96:99], v[112:115], v[0:15]
    s_waitcnt lgkmcnt(8)
    v_mfma_f32_32x32x16_bf16 v[16:31], v[96:99], v[116:119], v[16:31]
    s_waitcnt lgkmcnt(7)
    v_mfma_f32_32x32x16_bf16 v[32:47], v[96:99], v[120:123], v[32:47]
    v_mfma_f32_32x32x16_bf16 v[48:63], v[100:103], v[112:115], v[48:63]
    v_mfma_f32_32x32x16_bf16 v[64:79], v[100:103], v[116:119], v[64:79]
    v_mfma_f32_32x32x16_bf16 v[80:95], v[100:103], v[120:123], v[80:95]
    s_waitcnt lgkmcnt(2)
    v_mfma_f32_32x32x16_bf16 v[0:15], v[104:107], v[124:127], v[0:15]
    s_waitcnt lgkmcnt(1)
    v_mfma_f32_32x32x16_bf16 v[16:31], v[104:107], v[128:131], v[16:31]
    s_waitcnt lgkmcnt(0)
    v_mfma_f32_32x32x16_bf16 v[32:47], v[104:107], v[132:135], v[32:47]
    v_mfma_f32_32x32x16_bf16 v[48:63], v[108:111], v[124:127], v[48:63]
    v_mfma_f32_32x32x16_bf16 v[64:79], v[108:111], v[128:131], v[64:79]
    v_mfma_f32_32x32x16_bf16 v[80:95], v[108:111], v[132:135], v[80:95]
    s_barrier
    ds_read_b64_tr_b16 v[96:97], v228 offset:32768
    ds_read_b64_tr_b16 v[98:99], v228 offset:33792
    ds_read_b64_tr_b16 v[100:101], v228 offset:40960
    ds_read_b64_tr_b16 v[102:103], v228 offset:41984
    ds_read_b128 v[112:115], v229 offset:0
    ds_read_b128 v[116:119], v229 offset:4096
    ds_read_b128 v[120:123], v229 offset:8192
    ds_read_b64_tr_b16 v[104:105], v228 offset:36864
    ds_read_b64_tr_b16 v[106:107], v228 offset:37888
    ds_read_b64_tr_b16 v[108:109], v228 offset:45056
    ds_read_b64_tr_b16 v[110:111], v228 offset:46080
    ds_read_b128 v[124:127], v230 offset:0
    ds_read_b128 v[128:131], v230 offset:4096
    ds_read_b128 v[132:135], v230 offset:8192
    s_waitcnt lgkmcnt(9)
    v_mfma_f32_32x32x16_bf16 v[0:15], v[96:99], v[112:115], v[0:15]
    s_waitcnt lgkmcnt(8)
    v_mfma_f32_32x32x16_bf16 v[16:31], v[96:99], v[116:119], v[16:31]
    s_waitcnt lgkmcnt(7)
    v_mfma_f32_32x32x16_bf16 v[32:47], v[96:99], v[120:123], v[32:47]
    v_mfma_f32_32x32x16_bf16 v[48:63], v[100:103], v[112:115], v[48:63]
    v_mfma_f32_32x32x16_bf16 v[64:79], v[100:103], v[116:119], v[64:79]
    v_mfma_f32_32x32x16_bf16 v[80:95], v[100:103], v[120:123], v[80:95]
    s_waitcnt lgkmcnt(2)
    v_mfma_f32_32x32x16_bf16 v[0:15], v[104:107], v[124:127], v[0:15]
    s_waitcnt lgkmcnt(1)
    v_mfma_f32_32x32x16_bf16 v[16:31], v[104:107], v[128:131], v[16:31]
    s_waitcnt lgkmcnt(0)
    v_mfma_f32_32x32x16_bf16 v[32:47], v[104:107], v[132:135], v[32:47]
    v_mfma_f32_32x32x16_bf16 v[48:63], v[108:111], v[124:127], v[48:63]
    v_mfma_f32_32x32x16_bf16 v[64:79], v[108:111], v[128:131], v[64:79]
    v_mfma_f32_32x32x16_bf16 v[80:95], v[108:111], v[132:135], v[80:95]
    s_barrier
    ds_read_b64_tr_b16 v[96:97], v228 offset:0
    ds_read_b64_tr_b16 v[98:99], v228 offset:1024
    ds_read_b64_tr_b16 v[100:101], v228 offset:8192
    ds_read_b64_tr_b16 v[102:103], v228 offset:9216
    ds_read_b128 v[112:115], v231 offset:0
    ds_read_b128 v[116:119], v231 offset:4096
    ds_read_b128 v[120:123], v231 offset:8192
    ds_read_b64_tr_b16 v[104:105], v228 offset:4096
    ds_read_b64_tr_b16 v[106:107], v228 offset:5120
    ds_read_b64_tr_b16 v[108:109], v228 offset:12288
    ds_read_b64_tr_b16 v[110:111], v228 offset:13312
    ds_read_b128 v[124:127], v232 offset:0
    ds_read_b128 v[128:131], v232 offset:4096
    ds_read_b128 v[132:135], v232 offset:8192
    s_waitcnt lgkmcnt(9)
    v_mfma_f32_32x32x16_bf16 v[0:15], v[96:99], v[112:115], v[0:15]
    s_waitcnt lgkmcnt(8)
    v_mfma_f32_32x32x16_bf16 v[16:31], v[96:99], v[116:119], v[16:31]
    s_waitcnt lgkmcnt(7)
    v_mfma_f32_32x32x16_bf16 v[32:47], v[96:99], v[120:123], v[32:47]
    v_mfma_f32_32x32x16_bf16 v[48:63], v[100:103], v[112:115], v[48:63]
    v_mfma_f32_32x32x16_bf16 v[64:79], v[100:103], v[116:119], v[64:79]
    v_mfma_f32_32x32x16_bf16 v[80:95], v[100:103], v[120:123], v[80:95]
    s_waitcnt lgkmcnt(2)
    v_mfma_f32_32x32x16_bf16 v[0:15], v[104:107], v[124:127], v[0:15]
    s_waitcnt lgkmcnt(1)
    v_mfma_f32_32x32x16_bf16 v[16:31], v[104:107], v[128:131], v[16:31]
    s_waitcnt lgkmcnt(0)
    v_mfma_f32_32x32x16_bf16 v[32:47], v[104:107], v[132:135], v[32:47]
    v_mfma_f32_32x32x16_bf16 v[48:63], v[108:111], v[124:127], v[48:63]
    v_mfma_f32_32x32x16_bf16 v[64:79], v[108:111], v[128:131], v[64:79]
    v_mfma_f32_32x32x16_bf16 v[80:95], v[108:111], v[132:135], v[80:95]
    s_barrier
    ds_read_b64_tr_b16 v[96:97], v228 offset:16384
    ds_read_b64_tr_b16 v[98:99], v228 offset:17408
    ds_read_b64_tr_b16 v[100:101], v228 offset:24576
    ds_read_b64_tr_b16 v[102:103], v228 offset:25600
    ds_read_b128 v[112:115], v229 offset:12288
    ds_read_b128 v[116:119], v229 offset:16384
    ds_read_b128 v[120:123], v229 offset:20480
    ds_read_b64_tr_b16 v[104:105], v228 offset:20480
    ds_read_b64_tr_b16 v[106:107], v228 offset:21504
    ds_read_b64_tr_b16 v[108:109], v228 offset:28672
    ds_read_b64_tr_b16 v[110:111], v228 offset:29696
    ds_read_b128 v[124:127], v230 offset:12288
    ds_read_b128 v[128:131], v230 offset:16384
    ds_read_b128 v[132:135], v230 offset:20480
    s_waitcnt lgkmcnt(9)
    v_mfma_f32_32x32x16_bf16 v[0:15], v[96:99], v[112:115], v[0:15]
    s_waitcnt lgkmcnt(8)
    v_mfma_f32_32x32x16_bf16 v[16:31], v[96:99], v[116:119], v[16:31]
    s_waitcnt lgkmcnt(7)
    v_mfma_f32_32x32x16_bf16 v[32:47], v[96:99], v[120:123], v[32:47]
    v_mfma_f32_32x32x16_bf16 v[48:63], v[100:103], v[112:115], v[48:63]
    v_mfma_f32_32x32x16_bf16 v[64:79], v[100:103], v[116:119], v[64:79]
    v_mfma_f32_32x32x16_bf16 v[80:95], v[100:103], v[120:123], v[80:95]
    s_waitcnt lgkmcnt(2)
    v_mfma_f32_32x32x16_bf16 v[0:15], v[104:107], v[124:127], v[0:15]
    s_waitcnt lgkmcnt(1)
    v_mfma_f32_32x32x16_bf16 v[16:31], v[104:107], v[128:131], v[16:31]
    s_waitcnt lgkmcnt(0)
    v_mfma_f32_32x32x16_bf16 v[32:47], v[104:107], v[132:135], v[32:47]
    v_mfma_f32_32x32x16_bf16 v[48:63], v[108:111], v[124:127], v[48:63]
    v_mfma_f32_32x32x16_bf16 v[64:79], v[108:111], v[128:131], v[64:79]
    v_mfma_f32_32x32x16_bf16 v[80:95], v[108:111], v[132:135], v[80:95]
    s_barrier
    ds_read_b64_tr_b16 v[96:97], v228 offset:32768
    ds_read_b64_tr_b16 v[98:99], v228 offset:33792
    ds_read_b64_tr_b16 v[100:101], v228 offset:40960
    ds_read_b64_tr_b16 v[102:103], v228 offset:41984
    ds_read_b128 v[112:115], v231 offset:12288
    ds_read_b128 v[116:119], v231 offset:16384
    ds_read_b128 v[120:123], v231 offset:20480
    ds_read_b64_tr_b16 v[104:105], v228 offset:36864
    ds_read_b64_tr_b16 v[106:107], v228 offset:37888
    ds_read_b64_tr_b16 v[108:109], v228 offset:45056
    ds_read_b64_tr_b16 v[110:111], v228 offset:46080
    ds_read_b128 v[124:127], v232 offset:12288
    ds_read_b128 v[128:131], v232 offset:16384
    ds_read_b128 v[132:135], v232 offset:20480
    s_waitcnt lgkmcnt(9)
    v_mfma_f32_32x32x16_bf16 v[0:15], v[96:99], v[112:115], v[0:15]
    s_waitcnt lgkmcnt(8)
    v_mfma_f32_32x32x16_bf16 v[16:31], v[96:99], v[116:119], v[16:31]
    s_waitcnt lgkmcnt(7)
    v_mfma_f32_32x32x16_bf16 v[32:47], v[96:99], v[120:123], v[32:47]
    v_mfma_f32_32x32x16_bf16 v[48:63], v[100:103], v[112:115], v[48:63]
    v_mfma_f32_32x32x16_bf16 v[64:79], v[100:103], v[116:119], v[64:79]
    v_mfma_f32_32x32x16_bf16 v[80:95], v[100:103], v[120:123], v[80:95]
    s_waitcnt lgkmcnt(2)
    v_mfma_f32_32x32x16_bf16 v[0:15], v[104:107], v[124:127], v[0:15]
    s_waitcnt lgkmcnt(1)
    v_mfma_f32_32x32x16_bf16 v[16:31], v[104:107], v[128:131], v[16:31]
    s_waitcnt lgkmcnt(0)
    v_mfma_f32_32x32x16_bf16 v[32:47], v[104:107], v[132:135], v[32:47]
    v_mfma_f32_32x32x16_bf16 v[48:63], v[108:111], v[124:127], v[48:63]
    v_mfma_f32_32x32x16_bf16 v[64:79], v[108:111], v[128:131], v[64:79]
    v_mfma_f32_32x32x16_bf16 v[80:95], v[108:111], v[132:135], v[80:95]
    s_barrier
    ds_read_b64_tr_b16 v[96:97], v228 offset:0
    ds_read_b64_tr_b16 v[98:99], v228 offset:1024
    ds_read_b64_tr_b16 v[100:101], v228 offset:8192
    ds_read_b64_tr_b16 v[102:103], v228 offset:9216
    ds_read_b128 v[112:115], v229 offset:0
    ds_read_b128 v[116:119], v229 offset:4096
    ds_read_b128 v[120:123], v229 offset:8192
    ds_read_b64_tr_b16 v[104:105], v228 offset:4096
    ds_read_b64_tr_b16 v[106:107], v228 offset:5120
    ds_read_b64_tr_b16 v[108:109], v228 offset:12288
    ds_read_b64_tr_b16 v[110:111], v228 offset:13312
    ds_read_b128 v[124:127], v230 offset:0
    ds_read_b128 v[128:131], v230 offset:4096
    ds_read_b128 v[132:135], v230 offset:8192
    s_waitcnt lgkmcnt(9)
    v_mfma_f32_32x32x16_bf16 v[0:15], v[96:99], v[112:115], v[0:15]
    s_waitcnt lgkmcnt(8)
    v_mfma_f32_32x32x16_bf16 v[16:31], v[96:99], v[116:119], v[16:31]
    s_waitcnt lgkmcnt(7)
    v_mfma_f32_32x32x16_bf16 v[32:47], v[96:99], v[120:123], v[32:47]
    v_mfma_f32_32x32x16_bf16 v[48:63], v[100:103], v[112:115], v[48:63]
    v_mfma_f32_32x32x16_bf16 v[64:79], v[100:103], v[116:119], v[64:79]
    v_mfma_f32_32x32x16_bf16 v[80:95], v[100:103], v[120:123], v[80:95]
    s_waitcnt lgkmcnt(2)
    v_mfma_f32_32x32x16_bf16 v[0:15], v[104:107], v[124:127], v[0:15]
    s_waitcnt lgkmcnt(1)
    v_mfma_f32_32x32x16_bf16 v[16:31], v[104:107], v[128:131], v[16:31]
    s_waitcnt lgkmcnt(0)
    v_mfma_f32_32x32x16_bf16 v[32:47], v[104:107], v[132:135], v[32:47]
    v_mfma_f32_32x32x16_bf16 v[48:63], v[108:111], v[124:127], v[48:63]
    v_mfma_f32_32x32x16_bf16 v[64:79], v[108:111], v[128:131], v[64:79]
    v_mfma_f32_32x32x16_bf16 v[80:95], v[108:111], v[132:135], v[80:95]
    s_barrier
    ds_read_b64_tr_b16 v[96:97], v228 offset:16384
    ds_read_b64_tr_b16 v[98:99], v228 offset:17408
    ds_read_b64_tr_b16 v[100:101], v228 offset:24576
    ds_read_b64_tr_b16 v[102:103], v228 offset:25600
    ds_read_b128 v[112:115], v231 offset:0
    ds_read_b128 v[116:119], v231 offset:4096
    ds_read_b128 v[120:123], v231 offset:8192
    ds_read_b64_tr_b16 v[104:105], v228 offset:20480
    ds_read_b64_tr_b16 v[106:107], v228 offset:21504
    ds_read_b64_tr_b16 v[108:109], v228 offset:28672
    ds_read_b64_tr_b16 v[110:111], v228 offset:29696
    ds_read_b128 v[124:127], v232 offset:0
    ds_read_b128 v[128:131], v232 offset:4096
    ds_read_b128 v[132:135], v232 offset:8192
    s_waitcnt lgkmcnt(9)
    v_mfma_f32_32x32x16_bf16 v[0:15], v[96:99], v[112:115], v[0:15]
    s_waitcnt lgkmcnt(8)
    v_mfma_f32_32x32x16_bf16 v[16:31], v[96:99], v[116:119], v[16:31]
    s_waitcnt lgkmcnt(7)
    v_mfma_f32_32x32x16_bf16 v[32:47], v[96:99], v[120:123], v[32:47]
    v_mfma_f32_32x32x16_bf16 v[48:63], v[100:103], v[112:115], v[48:63]
    v_mfma_f32_32x32x16_bf16 v[64:79], v[100:103], v[116:119], v[64:79]
    v_mfma_f32_32x32x16_bf16 v[80:95], v[100:103], v[120:123], v[80:95]
    s_waitcnt lgkmcnt(2)
    v_mfma_f32_32x32x16_bf16 v[0:15], v[104:107], v[124:127], v[0:15]
    s_waitcnt lgkmcnt(1)
    v_mfma_f32_32x32x16_bf16 v[16:31], v[104:107], v[128:131], v[16:31]
    s_waitcnt lgkmcnt(0)
    v_mfma_f32_32x32x16_bf16 v[32:47], v[104:107], v[132:135], v[32:47]
    v_mfma_f32_32x32x16_bf16 v[48:63], v[108:111], v[124:127], v[48:63]
    v_mfma_f32_32x32x16_bf16 v[64:79], v[108:111], v[128:131], v[64:79]
    v_mfma_f32_32x32x16_bf16 v[80:95], v[108:111], v[132:135], v[80:95]
    s_barrier
    ds_read_b64_tr_b16 v[96:97], v228 offset:32768
    ds_read_b64_tr_b16 v[98:99], v228 offset:33792
    ds_read_b64_tr_b16 v[100:101], v228 offset:40960
    ds_read_b64_tr_b16 v[102:103], v228 offset:41984
    ds_read_b128 v[112:115], v229 offset:12288
    ds_read_b128 v[116:119], v229 offset:16384
    ds_read_b128 v[120:123], v229 offset:20480
    ds_read_b64_tr_b16 v[104:105], v228 offset:36864
    ds_read_b64_tr_b16 v[106:107], v228 offset:37888
    ds_read_b64_tr_b16 v[108:109], v228 offset:45056
    ds_read_b64_tr_b16 v[110:111], v228 offset:46080
    ds_read_b128 v[124:127], v230 offset:12288
    ds_read_b128 v[128:131], v230 offset:16384
    ds_read_b128 v[132:135], v230 offset:20480
    s_waitcnt lgkmcnt(9)
    v_mfma_f32_32x32x16_bf16 v[0:15], v[96:99], v[112:115], v[0:15]
    s_waitcnt lgkmcnt(8)
    v_mfma_f32_32x32x16_bf16 v[16:31], v[96:99], v[116:119], v[16:31]
    s_waitcnt lgkmcnt(7)
    v_mfma_f32_32x32x16_bf16 v[32:47], v[96:99], v[120:123], v[32:47]
    v_mfma_f32_32x32x16_bf16 v[48:63], v[100:103], v[112:115], v[48:63]
    v_mfma_f32_32x32x16_bf16 v[64:79], v[100:103], v[116:119], v[64:79]
    v_mfma_f32_32x32x16_bf16 v[80:95], v[100:103], v[120:123], v[80:95]
    s_waitcnt lgkmcnt(2)
    v_mfma_f32_32x32x16_bf16 v[0:15], v[104:107], v[124:127], v[0:15]
    s_waitcnt lgkmcnt(1)
    v_mfma_f32_32x32x16_bf16 v[16:31], v[104:107], v[128:131], v[16:31]
    s_waitcnt lgkmcnt(0)
    v_mfma_f32_32x32x16_bf16 v[32:47], v[104:107], v[132:135], v[32:47]
    v_mfma_f32_32x32x16_bf16 v[48:63], v[108:111], v[124:127], v[48:63]
    v_mfma_f32_32x32x16_bf16 v[64:79], v[108:111], v[128:131], v[64:79]
    v_mfma_f32_32x32x16_bf16 v[80:95], v[108:111], v[132:135], v[80:95]
    s_barrier
    ds_read_b64_tr_b16 v[96:97], v228 offset:0
    ds_read_b64_tr_b16 v[98:99], v228 offset:1024
    ds_read_b64_tr_b16 v[100:101], v228 offset:8192
    ds_read_b64_tr_b16 v[102:103], v228 offset:9216
    ds_read_b128 v[112:115], v231 offset:12288
    ds_read_b128 v[116:119], v231 offset:16384
    ds_read_b128 v[120:123], v231 offset:20480
    ds_read_b64_tr_b16 v[104:105], v228 offset:4096
    ds_read_b64_tr_b16 v[106:107], v228 offset:5120
    ds_read_b64_tr_b16 v[108:109], v228 offset:12288
    ds_read_b64_tr_b16 v[110:111], v228 offset:13312
    ds_read_b128 v[124:127], v232 offset:12288
    ds_read_b128 v[128:131], v232 offset:16384
    ds_read_b128 v[132:135], v232 offset:20480
    s_waitcnt lgkmcnt(9)
    v_mfma_f32_32x32x16_bf16 v[0:15], v[96:99], v[112:115], v[0:15]
    s_waitcnt lgkmcnt(8)
    v_mfma_f32_32x32x16_bf16 v[16:31], v[96:99], v[116:119], v[16:31]
    s_waitcnt lgkmcnt(7)
    v_mfma_f32_32x32x16_bf16 v[32:47], v[96:99], v[120:123], v[32:47]
    v_mfma_f32_32x32x16_bf16 v[48:63], v[100:103], v[112:115], v[48:63]
    v_mfma_f32_32x32x16_bf16 v[64:79], v[100:103], v[116:119], v[64:79]
    v_mfma_f32_32x32x16_bf16 v[80:95], v[100:103], v[120:123], v[80:95]
    s_waitcnt lgkmcnt(2)
    v_mfma_f32_32x32x16_bf16 v[0:15], v[104:107], v[124:127], v[0:15]
    s_waitcnt lgkmcnt(1)
    v_mfma_f32_32x32x16_bf16 v[16:31], v[104:107], v[128:131], v[16:31]
    s_waitcnt lgkmcnt(0)
    v_mfma_f32_32x32x16_bf16 v[32:47], v[104:107], v[132:135], v[32:47]
    v_mfma_f32_32x32x16_bf16 v[48:63], v[108:111], v[124:127], v[48:63]
    v_mfma_f32_32x32x16_bf16 v[64:79], v[108:111], v[128:131], v[64:79]
    v_mfma_f32_32x32x16_bf16 v[80:95], v[108:111], v[132:135], v[80:95]
    s_barrier
    s_mov_b32 s76, 0x3e0293ee
    s_mov_b32 s77, 0x3e0293ee
    s_nop 3
    v_pk_mul_f32 v[0:1], v[0:1], s[76:77]
    v_pk_mul_f32 v[2:3], v[2:3], s[76:77]
    v_pk_mul_f32 v[4:5], v[4:5], s[76:77]
    v_pk_mul_f32 v[6:7], v[6:7], s[76:77]
    v_pk_mul_f32 v[8:9], v[8:9], s[76:77]
    v_pk_mul_f32 v[10:11], v[10:11], s[76:77]
    v_pk_mul_f32 v[12:13], v[12:13], s[76:77]
    v_pk_mul_f32 v[14:15], v[14:15], s[76:77]
    v_cvt_pk_bf16_f32 v0, v0, v1
    v_cvt_pk_bf16_f32 v1, v2, v3
    v_cvt_pk_bf16_f32 v2, v4, v5
    v_cvt_pk_bf16_f32 v3, v6, v7
    v_cvt_pk_bf16_f32 v4, v8, v9
    v_cvt_pk_bf16_f32 v5, v10, v11
    v_cvt_pk_bf16_f32 v6, v12, v13
    v_cvt_pk_bf16_f32 v7, v14, v15
    ds_write_b128 v233, v[0:3] offset:0
    ds_write_b128 v233, v[4:7] offset:1024
    v_pk_mul_f32 v[16:17], v[16:17], s[76:77]
    v_pk_mul_f32 v[18:19], v[18:19], s[76:77]
    v_pk_mul_f32 v[20:21], v[20:21], s[76:77]
    v_pk_mul_f32 v[22:23], v[22:23], s[76:77]
    v_pk_mul_f32 v[24:25], v[24:25], s[76:77]
    v_pk_mul_f32 v[26:27], v[26:27], s[76:77]
    v_pk_mul_f32 v[28:29], v[28:29], s[76:77]
    v_pk_mul_f32 v[30:31], v[30:31], s[76:77]
    v_cvt_pk_bf16_f32 v16, v16, v17
    v_cvt_pk_bf16_f32 v17, v18, v19
    v_cvt_pk_bf16_f32 v18, v20, v21
    v_cvt_pk_bf16_f32 v19, v22, v23
    v_cvt_pk_bf16_f32 v20, v24, v25
    v_cvt_pk_bf16_f32 v21, v26, v27
    v_cvt_pk_bf16_f32 v22, v28, v29
    v_cvt_pk_bf16_f32 v23, v30, v31
    ds_write_b128 v233, v[16:19] offset:8192
    ds_write_b128 v233, v[20:23] offset:9216
    v_pk_mul_f32 v[32:33], v[32:33], s[76:77]
    v_pk_mul_f32 v[34:35], v[34:35], s[76:77]
    v_pk_mul_f32 v[36:37], v[36:37], s[76:77]
    v_pk_mul_f32 v[38:39], v[38:39], s[76:77]
    v_pk_mul_f32 v[40:41], v[40:41], s[76:77]
    v_pk_mul_f32 v[42:43], v[42:43], s[76:77]
    v_pk_mul_f32 v[44:45], v[44:45], s[76:77]
    v_pk_mul_f32 v[46:47], v[46:47], s[76:77]
    v_cvt_pk_bf16_f32 v32, v32, v33
    v_cvt_pk_bf16_f32 v33, v34, v35
    v_cvt_pk_bf16_f32 v34, v36, v37
    v_cvt_pk_bf16_f32 v35, v38, v39
    v_cvt_pk_bf16_f32 v36, v40, v41
    v_cvt_pk_bf16_f32 v37, v42, v43
    v_cvt_pk_bf16_f32 v38, v44, v45
    v_cvt_pk_bf16_f32 v39, v46, v47
    ds_write_b128 v233, v[32:35] offset:16384
    ds_write_b128 v233, v[36:39] offset:17408
    v_pk_mul_f32 v[48:49], v[48:49], s[76:77]
    v_pk_mul_f32 v[50:51], v[50:51], s[76:77]
    v_pk_mul_f32 v[52:53], v[52:53], s[76:77]
    v_pk_mul_f32 v[54:55], v[54:55], s[76:77]
    v_pk_mul_f32 v[56:57], v[56:57], s[76:77]
    v_pk_mul_f32 v[58:59], v[58:59], s[76:77]
    v_pk_mul_f32 v[60:61], v[60:61], s[76:77]
    v_pk_mul_f32 v[62:63], v[62:63], s[76:77]
    v_cvt_pk_bf16_f32 v48, v48, v49
    v_cvt_pk_bf16_f32 v49, v50, v51
    v_cvt_pk_bf16_f32 v50, v52, v53
    v_cvt_pk_bf16_f32 v51, v54, v55
    v_cvt_pk_bf16_f32 v52, v56, v57
    v_cvt_pk_bf16_f32 v53, v58, v59
    v_cvt_pk_bf16_f32 v54, v60, v61
    v_cvt_pk_bf16_f32 v55, v62, v63
    ds_write_b128 v233, v[48:51] offset:24576
    ds_write_b128 v233, v[52:55] offset:25600
    v_pk_mul_f32 v[64:65], v[64:65], s[76:77]
    v_pk_mul_f32 v[66:67], v[66:67], s[76:77]
    v_pk_mul_f32 v[68:69], v[68:69], s[76:77]
    v_pk_mul_f32 v[70:71], v[70:71], s[76:77]
    v_pk_mul_f32 v[72:73], v[72:73], s[76:77]
    v_pk_mul_f32 v[74:75], v[74:75], s[76:77]
    v_pk_mul_f32 v[76:77], v[76:77], s[76:77]
    v_pk_mul_f32 v[78:79], v[78:79], s[76:77]
    v_cvt_pk_bf16_f32 v64, v64, v65
    v_cvt_pk_bf16_f32 v65, v66, v67
    v_cvt_pk_bf16_f32 v66, v68, v69
    v_cvt_pk_bf16_f32 v67, v70, v71
    v_cvt_pk_bf16_f32 v68, v72, v73
    v_cvt_pk_bf16_f32 v69, v74, v75
    v_cvt_pk_bf16_f32 v70, v76, v77
    v_cvt_pk_bf16_f32 v71, v78, v79
    ds_write_b128 v233, v[64:67] offset:32768
    ds_write_b128 v233, v[68:71] offset:33792
    v_pk_mul_f32 v[80:81], v[80:81], s[76:77]
    v_pk_mul_f32 v[82:83], v[82:83], s[76:77]
    v_pk_mul_f32 v[84:85], v[84:85], s[76:77]
    v_pk_mul_f32 v[86:87], v[86:87], s[76:77]
    v_pk_mul_f32 v[88:89], v[88:89], s[76:77]
    v_pk_mul_f32 v[90:91], v[90:91], s[76:77]
    v_pk_mul_f32 v[92:93], v[92:93], s[76:77]
    v_pk_mul_f32 v[94:95], v[94:95], s[76:77]
    v_cvt_pk_bf16_f32 v80, v80, v81
    v_cvt_pk_bf16_f32 v81, v82, v83
    v_cvt_pk_bf16_f32 v82, v84, v85
    v_cvt_pk_bf16_f32 v83, v86, v87
    v_cvt_pk_bf16_f32 v84, v88, v89
    v_cvt_pk_bf16_f32 v85, v90, v91
    v_cvt_pk_bf16_f32 v86, v92, v93
    v_cvt_pk_bf16_f32 v87, v94, v95
    ds_write_b128 v233, v[80:83] offset:40960
    ds_write_b128 v233, v[84:87] offset:41984
    s_waitcnt lgkmcnt(0)
    s_barrier
    s_add_u32 s76, s75, 0
    s_and_b32 s76, s76, 7
    s_lshl_b32 s76, s76, 10
    v_add_u32 v234, s76, v226
    ds_read_b128 v[208:211], v234 offset:0
    ds_read_b128 v[212:215], v234 offset:8192
    ds_read_b128 v[216:219], v234 offset:16384
    ds_read_b64_tr_b16 v[192:193], v222 offset:0
    ds_read_b64_tr_b16 v[194:195], v222 offset:1024
    ds_read_b64_tr_b16 v[196:197], v223 offset:0
    ds_read_b64_tr_b16 v[198:199], v223 offset:1024
    s_waitcnt lgkmcnt(2)
    v_mfma_f32_32x32x16_bf16 v[0:15], v[192:195], v[208:211], 0
    v_mfma_f32_32x32x16_bf16 v[16:31], v[192:195], v[212:215], 0
    v_mfma_f32_32x32x16_bf16 v[32:47], v[192:195], v[216:219], 0
    s_waitcnt lgkmcnt(0)
    v_mfma_f32_32x32x16_bf16 v[48:63], v[196:199], v[208:211], 0
    v_mfma_f32_32x32x16_bf16 v[64:79], v[196:199], v[212:215], 0
    v_mfma_f32_32x32x16_bf16 v[80:95], v[196:199], v[216:219], 0
    s_barrier
    ds_read_b64_tr_b16 v[192:193], v222 offset:8192
    ds_read_b64_tr_b16 v[194:195], v222 offset:9216
    ds_read_b64_tr_b16 v[196:197], v223 offset:8192
    ds_read_b64_tr_b16 v[198:199], v223 offset:9216
    s_waitcnt lgkmcnt(2)
    v_mfma_f32_32x32x16_bf16 v[96:111], v[192:195], v[208:211], 0
    v_mfma_f32_32x32x16_bf16 v[112:127], v[192:195], v[212:215], 0
    v_mfma_f32_32x32x16_bf16 v[128:143], v[192:195], v[216:219], 0
    s_waitcnt lgkmcnt(0)
    v_mfma_f32_32x32x16_bf16 v[144:159], v[196:199], v[208:211], 0
    v_mfma_f32_32x32x16_bf16 v[160:175], v[196:199], v[212:215], 0
    v_mfma_f32_32x32x16_bf16 v[176:191], v[196:199], v[216:219], 0
    s_barrier
    s_add_u32 s76, s75, 1
    s_and_b32 s76, s76, 7
    s_lshl_b32 s76, s76, 10
    v_add_u32 v234, s76, v226
    ds_read_b128 v[208:211], v234 offset:0
    ds_read_b128 v[212:215], v234 offset:8192
    ds_read_b128 v[216:219], v234 offset:16384
    ds_read_b64_tr_b16 v[192:193], v222 offset:16384
    ds_read_b64_tr_b16 v[194:195], v222 offset:17408
    ds_read_b64_tr_b16 v[196:197], v223 offset:16384
    ds_read_b64_tr_b16 v[198:199], v223 offset:17408
    s_waitcnt lgkmcnt(2)
    v_mfma_f32_32x32x16_bf16 v[0:15], v[192:195], v[208:211], v[0:15]
    v_mfma_f32_32x32x16_bf16 v[16:31], v[192:195], v[212:215], v[16:31]
    v_mfma_f32_32x32x16_bf16 v[32:47], v[192:195], v[216:219], v[32:47]
    s_waitcnt lgkmcnt(0)
    v_mfma_f32_32x32x16_bf16 v[48:63], v[196:199], v[208:211], v[48:63]
    v_mfma_f32_32x32x16_bf16 v[64:79], v[196:199], v[212:215], v[64:79]
    v_mfma_f32_32x32x16_bf16 v[80:95], v[196:199], v[216:219], v[80:95]
    s_barrier
    ds_read_b64_tr_b16 v[192:193], v222 offset:0
    ds_read_b64_tr_b16 v[194:195], v222 offset:1024
    ds_read_b64_tr_b16 v[196:197], v223 offset:0
    ds_read_b64_tr_b16 v[198:199], v223 offset:1024
    s_waitcnt lgkmcnt(2)
    v_mfma_f32_32x32x16_bf16 v[96:111], v[192:195], v[208:211], v[96:111]
    v_mfma_f32_32x32x16_bf16 v[112:127], v[192:195], v[212:215], v[112:127]
    v_mfma_f32_32x32x16_bf16 v[128:143], v[192:195], v[216:219], v[128:143]
    s_waitcnt lgkmcnt(0)
    v_mfma_f32_32x32x16_bf16 v[144:159], v[196:199], v[208:211], v[144:159]
    v_mfma_f32_32x32x16_bf16 v[160:175], v[196:199], v[212:215], v[160:175]
    v_mfma_f32_32x32x16_bf16 v[176:191], v[196:199], v[216:219], v[176:191]
    s_barrier
    s_add_u32 s76, s75, 2
    s_and_b32 s76, s76, 7
    s_lshl_b32 s76, s76, 10
    v_add_u32 v234, s76, v226
    ds_read_b128 v[208:211], v234 offset:0
    ds_read_b128 v[212:215], v234 offset:8192
    ds_read_b128 v[216:219], v234 offset:16384
    ds_read_b64_tr_b16 v[192:193], v222 offset:8192
    ds_read_b64_tr_b16 v[194:195], v222 offset:9216
    ds_read_b64_tr_b16 v[196:197], v223 offset:8192
    ds_read_b64_tr_b16 v[198:199], v223 offset:9216
    s_waitcnt lgkmcnt(2)
    v_mfma_f32_32x32x16_bf16 v[0:15], v[192:195], v[208:211], v[0:15]
    v_mfma_f32_32x32x16_bf16 v[16:31], v[192:195], v[212:215], v[16:31]
    v_mfma_f32_32x32x16_bf16 v[32:47], v[192:195], v[216:219], v[32:47]
    s_waitcnt lgkmcnt(0)
    v_mfma_f32_32x32x16_bf16 v[48:63], v[196:199], v[208:211], v[48:63]
    v_mfma_f32_32x32x16_bf16 v[64:79], v[196:199], v[212:215], v[64:79]
    v_mfma_f32_32x32x16_bf16 v[80:95], v[196:199], v[216:219], v[80:95]
    s_barrier
    ds_read_b64_tr_b16 v[192:193], v222 offset:16384
    ds_read_b64_tr_b16 v[194:195], v222 offset:17408
    ds_read_b64_tr_b16 v[196:197], v223 offset:16384
    ds_read_b64_tr_b16 v[198:199], v223 offset:17408
    s_waitcnt lgkmcnt(2)
    v_mfma_f32_32x32x16_bf16 v[96:111], v[192:195], v[208:211], v[96:111]
    v_mfma_f32_32x32x16_bf16 v[112:127], v[192:195], v[212:215], v[112:127]
    v_mfma_f32_32x32x16_bf16 v[128:143], v[192:195], v[216:219], v[128:143]
    s_waitcnt lgkmcnt(0)
    v_mfma_f32_32x32x16_bf16 v[144:159], v[196:199], v[208:211], v[144:159]
    v_mfma_f32_32x32x16_bf16 v[160:175], v[196:199], v[212:215], v[160:175]
    v_mfma_f32_32x32x16_bf16 v[176:191], v[196:199], v[216:219], v[176:191]
    s_barrier
    s_add_u32 s76, s75, 3
    s_and_b32 s76, s76, 7
    s_lshl_b32 s76, s76, 10
    v_add_u32 v234, s76, v226
    ds_read_b128 v[208:211], v234 offset:0
    ds_read_b128 v[212:215], v234 offset:8192
    ds_read_b128 v[216:219], v234 offset:16384
    ds_read_b64_tr_b16 v[192:193], v222 offset:0
    ds_read_b64_tr_b16 v[194:195], v222 offset:1024
    ds_read_b64_tr_b16 v[196:197], v223 offset:0
    ds_read_b64_tr_b16 v[198:199], v223 offset:1024
    s_waitcnt lgkmcnt(2)
    v_mfma_f32_32x32x16_bf16 v[0:15], v[192:195], v[208:211], v[0:15]
    v_mfma_f32_32x32x16_bf16 v[16:31], v[192:195], v[212:215], v[16:31]
    v_mfma_f32_32x32x16_bf16 v[32:47], v[192:195], v[216:219], v[32:47]
    s_waitcnt lgkmcnt(0)
    v_mfma_f32_32x32x16_bf16 v[48:63], v[196:199], v[208:211], v[48:63]
    v_mfma_f32_32x32x16_bf16 v[64:79], v[196:199], v[212:215], v[64:79]
    v_mfma_f32_32x32x16_bf16 v[80:95], v[196:199], v[216:219], v[80:95]
    s_barrier
    ds_read_b64_tr_b16 v[192:193], v222 offset:8192
    ds_read_b64_tr_b16 v[194:195], v222 offset:9216
    ds_read_b64_tr_b16 v[196:197], v223 offset:8192
    ds_read_b64_tr_b16 v[198:199], v223 offset:9216
    s_waitcnt lgkmcnt(2)
    v_mfma_f32_32x32x16_bf16 v[96:111], v[192:195], v[208:211], v[96:111]
    v_mfma_f32_32x32x16_bf16 v[112:127], v[192:195], v[212:215], v[112:127]
    v_mfma_f32_32x32x16_bf16 v[128:143], v[192:195], v[216:219], v[128:143]
    s_waitcnt lgkmcnt(0)
    v_mfma_f32_32x32x16_bf16 v[144:159], v[196:199], v[208:211], v[144:159]
    v_mfma_f32_32x32x16_bf16 v[160:175], v[196:199], v[212:215], v[160:175]
    v_mfma_f32_32x32x16_bf16 v[176:191], v[196:199], v[216:219], v[176:191]
    s_barrier
    s_add_u32 s76, s75, 4
    s_and_b32 s76, s76, 7
    s_lshl_b32 s76, s76, 10
    v_add_u32 v234, s76, v226
    ds_read_b128 v[208:211], v234 offset:0
    ds_read_b128 v[212:215], v234 offset:8192
    ds_read_b128 v[216:219], v234 offset:16384
    ds_read_b64_tr_b16 v[192:193], v222 offset:16384
    ds_read_b64_tr_b16 v[194:195], v222 offset:17408
    ds_read_b64_tr_b16 v[196:197], v223 offset:16384
    ds_read_b64_tr_b16 v[198:199], v223 offset:17408
    s_waitcnt lgkmcnt(2)
    v_mfma_f32_32x32x16_bf16 v[0:15], v[192:195], v[208:211], v[0:15]
    v_mfma_f32_32x32x16_bf16 v[16:31], v[192:195], v[212:215], v[16:31]
    v_mfma_f32_32x32x16_bf16 v[32:47], v[192:195], v[216:219], v[32:47]
    s_waitcnt lgkmcnt(0)
    v_mfma_f32_32x32x16_bf16 v[48:63], v[196:199], v[208:211], v[48:63]
    v_mfma_f32_32x32x16_bf16 v[64:79], v[196:199], v[212:215], v[64:79]
    v_mfma_f32_32x32x16_bf16 v[80:95], v[196:199], v[216:219], v[80:95]
    s_barrier
    ds_read_b64_tr_b16 v[192:193], v222 offset:0
    ds_read_b64_tr_b16 v[194:195], v222 offset:1024
    ds_read_b64_tr_b16 v[196:197], v223 offset:0
    ds_read_b64_tr_b16 v[198:199], v223 offset:1024
    s_waitcnt lgkmcnt(2)
    v_mfma_f32_32x32x16_bf16 v[96:111], v[192:195], v[208:211], v[96:111]
    v_mfma_f32_32x32x16_bf16 v[112:127], v[192:195], v[212:215], v[112:127]
    v_mfma_f32_32x32x16_bf16 v[128:143], v[192:195], v[216:219], v[128:143]
    s_waitcnt lgkmcnt(0)
    v_mfma_f32_32x32x16_bf16 v[144:159], v[196:199], v[208:211], v[144:159]
    v_mfma_f32_32x32x16_bf16 v[160:175], v[196:199], v[212:215], v[160:175]
    v_mfma_f32_32x32x16_bf16 v[176:191], v[196:199], v[216:219], v[176:191]
    s_barrier
    s_add_u32 s76, s75, 5
    s_and_b32 s76, s76, 7
    s_lshl_b32 s76, s76, 10
    v_add_u32 v234, s76, v226
    ds_read_b128 v[208:211], v234 offset:0
    ds_read_b128 v[212:215], v234 offset:8192
    ds_read_b128 v[216:219], v234 offset:16384
    ds_read_b64_tr_b16 v[192:193], v222 offset:8192
    ds_read_b64_tr_b16 v[194:195], v222 offset:9216
    ds_read_b64_tr_b16 v[196:197], v223 offset:8192
    ds_read_b64_tr_b16 v[198:199], v223 offset:9216
    s_waitcnt lgkmcnt(2)
    v_mfma_f32_32x32x16_bf16 v[0:15], v[192:195], v[208:211], v[0:15]
    v_mfma_f32_32x32x16_bf16 v[16:31], v[192:195], v[212:215], v[16:31]
    v_mfma_f32_32x32x16_bf16 v[32:47], v[192:195], v[216:219], v[32:47]
    s_waitcnt lgkmcnt(0)
    v_mfma_f32_32x32x16_bf16 v[48:63], v[196:199], v[208:211], v[48:63]
    v_mfma_f32_32x32x16_bf16 v[64:79], v[196:199], v[212:215], v[64:79]
    v_mfma_f32_32x32x16_bf16 v[80:95], v[196:199], v[216:219], v[80:95]
    s_barrier
    ds_read_b64_tr_b16 v[192:193], v222 offset:16384
    ds_read_b64_tr_b16 v[194:195], v222 offset:17408
    ds_read_b64_tr_b16 v[196:197], v223 offset:16384
    ds_read_b64_tr_b16 v[198:199], v223 offset:17408
    s_waitcnt lgkmcnt(2)
    v_mfma_f32_32x32x16_bf16 v[96:111], v[192:195], v[208:211], v[96:111]
    v_mfma_f32_32x32x16_bf16 v[112:127], v[192:195], v[212:215], v[112:127]
    v_mfma_f32_32x32x16_bf16 v[128:143], v[192:195], v[216:219], v[128:143]
    s_waitcnt lgkmcnt(0)
    v_mfma_f32_32x32x16_bf16 v[144:159], v[196:199], v[208:211], v[144:159]
    v_mfma_f32_32x32x16_bf16 v[160:175], v[196:199], v[212:215], v[160:175]
    v_mfma_f32_32x32x16_bf16 v[176:191], v[196:199], v[216:219], v[176:191]
    s_barrier
    s_add_u32 s76, s75, 6
    s_and_b32 s76, s76, 7
    s_lshl_b32 s76, s76, 10
    v_add_u32 v234, s76, v226
    ds_read_b128 v[208:211], v234 offset:0
    ds_read_b128 v[212:215], v234 offset:8192
    ds_read_b128 v[216:219], v234 offset:16384
    ds_read_b64_tr_b16 v[192:193], v222 offset:0
    ds_read_b64_tr_b16 v[194:195], v222 offset:1024
    ds_read_b64_tr_b16 v[196:197], v223 offset:0
    ds_read_b64_tr_b16 v[198:199], v223 offset:1024
    s_waitcnt lgkmcnt(2)
    v_mfma_f32_32x32x16_bf16 v[0:15], v[192:195], v[208:211], v[0:15]
    v_mfma_f32_32x32x16_bf16 v[16:31], v[192:195], v[212:215], v[16:31]
    v_mfma_f32_32x32x16_bf16 v[32:47], v[192:195], v[216:219], v[32:47]
    s_waitcnt lgkmcnt(0)
    v_mfma_f32_32x32x16_bf16 v[48:63], v[196:199], v[208:211], v[48:63]
    v_mfma_f32_32x32x16_bf16 v[64:79], v[196:199], v[212:215], v[64:79]
    v_mfma_f32_32x32x16_bf16 v[80:95], v[196:199], v[216:219], v[80:95]
    s_barrier
    ds_read_b64_tr_b16 v[192:193], v222 offset:8192
    ds_read_b64_tr_b16 v[194:195], v222 offset:9216
    ds_read_b64_tr_b16 v[196:197], v223 offset:8192
    ds_read_b64_tr_b16 v[198:199], v223 offset:9216
    s_waitcnt lgkmcnt(2)
    v_mfma_f32_32x32x16_bf16 v[96:111], v[192:195], v[208:211], v[96:111]
    v_mfma_f32_32x32x16_bf16 v[112:127], v[192:195], v[212:215], v[112:127]
    v_mfma_f32_32x32x16_bf16 v[128:143], v[192:195], v[216:219], v[128:143]
    s_waitcnt lgkmcnt(0)
    v_mfma_f32_32x32x16_bf16 v[144:159], v[196:199], v[208:211], v[144:159]
    v_mfma_f32_32x32x16_bf16 v[160:175], v[196:199], v[212:215], v[160:175]
    v_mfma_f32_32x32x16_bf16 v[176:191], v[196:199], v[216:219], v[176:191]
    s_barrier
    s_add_u32 s76, s75, 7
    s_and_b32 s76, s76, 7
    s_lshl_b32 s76, s76, 10
    v_add_u32 v234, s76, v226
    ds_read_b128 v[208:211], v234 offset:0
    ds_read_b128 v[212:215], v234 offset:8192
    ds_read_b128 v[216:219], v234 offset:16384
    ds_read_b64_tr_b16 v[192:193], v222 offset:16384
    ds_read_b64_tr_b16 v[194:195], v222 offset:17408
    ds_read_b64_tr_b16 v[196:197], v223 offset:16384
    ds_read_b64_tr_b16 v[198:199], v223 offset:17408
    s_waitcnt lgkmcnt(2)
    v_mfma_f32_32x32x16_bf16 v[0:15], v[192:195], v[208:211], v[0:15]
    v_mfma_f32_32x32x16_bf16 v[16:31], v[192:195], v[212:215], v[16:31]
    v_mfma_f32_32x32x16_bf16 v[32:47], v[192:195], v[216:219], v[32:47]
    s_waitcnt lgkmcnt(0)
    v_mfma_f32_32x32x16_bf16 v[48:63], v[196:199], v[208:211], v[48:63]
    v_mfma_f32_32x32x16_bf16 v[64:79], v[196:199], v[212:215], v[64:79]
    v_mfma_f32_32x32x16_bf16 v[80:95], v[196:199], v[216:219], v[80:95]
    s_barrier
    ds_read_b64_tr_b16 v[192:193], v222 offset:0
    ds_read_b64_tr_b16 v[194:195], v222 offset:1024
    ds_read_b64_tr_b16 v[196:197], v223 offset:0
    ds_read_b64_tr_b16 v[198:199], v223 offset:1024
    s_waitcnt lgkmcnt(2)
    v_mfma_f32_32x32x16_bf16 v[96:111], v[192:195], v[208:211], v[96:111]
    v_mfma_f32_32x32x16_bf16 v[112:127], v[192:195], v[212:215], v[112:127]
    v_mfma_f32_32x32x16_bf16 v[128:143], v[192:195], v[216:219], v[128:143]
    s_waitcnt lgkmcnt(0)
    v_mfma_f32_32x32x16_bf16 v[144:159], v[196:199], v[208:211], v[144:159]
    v_mfma_f32_32x32x16_bf16 v[160:175], v[196:199], v[212:215], v[160:175]
    v_mfma_f32_32x32x16_bf16 v[176:191], v[196:199], v[216:219], v[176:191]
    s_barrier
    s_add_u32 s76, s75, 0
    s_and_b32 s76, s76, 7
    s_lshl_b32 s76, s76, 10
    v_add_u32 v234, s76, v226
    ds_read_b128 v[208:211], v234 offset:24576
    ds_read_b128 v[212:215], v234 offset:32768
    ds_read_b128 v[216:219], v234 offset:40960
    ds_read_b64_tr_b16 v[192:193], v222 offset:8192
    ds_read_b64_tr_b16 v[194:195], v222 offset:9216
    ds_read_b64_tr_b16 v[196:197], v223 offset:8192
    ds_read_b64_tr_b16 v[198:199], v223 offset:9216
    s_waitcnt lgkmcnt(2)
    v_mfma_f32_32x32x16_bf16 v[0:15], v[192:195], v[208:211], v[0:15]
    v_mfma_f32_32x32x16_bf16 v[16:31], v[192:195], v[212:215], v[16:31]
    v_mfma_f32_32x32x16_bf16 v[32:47], v[192:195], v[216:219], v[32:47]
    s_waitcnt lgkmcnt(0)
    v_mfma_f32_32x32x16_bf16 v[48:63], v[196:199], v[208:211], v[48:63]
    v_mfma_f32_32x32x16_bf16 v[64:79], v[196:199], v[212:215], v[64:79]
    v_mfma_f32_32x32x16_bf16 v[80:95], v[196:199], v[216:219], v[80:95]
    s_barrier
    ds_read_b64_tr_b16 v[192:193], v222 offset:16384
    ds_read_b64_tr_b16 v[194:195], v222 offset:17408
    ds_read_b64_tr_b16 v[196:197], v223 offset:16384
    ds_read_b64_tr_b16 v[198:199], v223 offset:17408
    s_waitcnt lgkmcnt(2)
    v_mfma_f32_32x32x16_bf16 v[96:111], v[192:195], v[208:211], v[96:111]
    v_mfma_f32_32x32x16_bf16 v[112:127], v[192:195], v[212:215], v[112:127]
    v_mfma_f32_32x32x16_bf16 v[128:143], v[192:195], v[216:219], v[128:143]
    s_waitcnt lgkmcnt(0)
    v_mfma_f32_32x32x16_bf16 v[144:159], v[196:199], v[208:211], v[144:159]
    v_mfma_f32_32x32x16_bf16 v[160:175], v[196:199], v[212:215], v[160:175]
    v_mfma_f32_32x32x16_bf16 v[176:191], v[196:199], v[216:219], v[176:191]
    s_barrier
    s_add_u32 s76, s75, 1
    s_and_b32 s76, s76, 7
    s_lshl_b32 s76, s76, 10
    v_add_u32 v234, s76, v226
    ds_read_b128 v[208:211], v234 offset:24576
    ds_read_b128 v[212:215], v234 offset:32768
    ds_read_b128 v[216:219], v234 offset:40960
    ds_read_b64_tr_b16 v[192:193], v222 offset:0
    ds_read_b64_tr_b16 v[194:195], v222 offset:1024
    ds_read_b64_tr_b16 v[196:197], v223 offset:0
    ds_read_b64_tr_b16 v[198:199], v223 offset:1024
    s_waitcnt lgkmcnt(2)
    v_mfma_f32_32x32x16_bf16 v[0:15], v[192:195], v[208:211], v[0:15]
    v_mfma_f32_32x32x16_bf16 v[16:31], v[192:195], v[212:215], v[16:31]
    v_mfma_f32_32x32x16_bf16 v[32:47], v[192:195], v[216:219], v[32:47]
    s_waitcnt lgkmcnt(0)
    v_mfma_f32_32x32x16_bf16 v[48:63], v[196:199], v[208:211], v[48:63]
    v_mfma_f32_32x32x16_bf16 v[64:79], v[196:199], v[212:215], v[64:79]
    v_mfma_f32_32x32x16_bf16 v[80:95], v[196:199], v[216:219], v[80:95]
    s_barrier
    ds_read_b64_tr_b16 v[192:193], v222 offset:8192
    ds_read_b64_tr_b16 v[194:195], v222 offset:9216
    ds_read_b64_tr_b16 v[196:197], v223 offset:8192
    ds_read_b64_tr_b16 v[198:199], v223 offset:9216
    s_waitcnt lgkmcnt(2)
    v_mfma_f32_32x32x16_bf16 v[96:111], v[192:195], v[208:211], v[96:111]
    v_mfma_f32_32x32x16_bf16 v[112:127], v[192:195], v[212:215], v[112:127]
    v_mfma_f32_32x32x16_bf16 v[128:143], v[192:195], v[216:219], v[128:143]
    s_waitcnt lgkmcnt(0)
    v_mfma_f32_32x32x16_bf16 v[144:159], v[196:199], v[208:211], v[144:159]
    v_mfma_f32_32x32x16_bf16 v[160:175], v[196:199], v[212:215], v[160:175]
    v_mfma_f32_32x32x16_bf16 v[176:191], v[196:199], v[216:219], v[176:191]
    s_barrier
    s_add_u32 s76, s75, 2
    s_and_b32 s76, s76, 7
    s_lshl_b32 s76, s76, 10
    v_add_u32 v234, s76, v226
    ds_read_b128 v[208:211], v234 offset:24576
    ds_read_b128 v[212:215], v234 offset:32768
    ds_read_b128 v[216:219], v234 offset:40960
    ds_read_b64_tr_b16 v[192:193], v222 offset:16384
    ds_read_b64_tr_b16 v[194:195], v222 offset:17408
    ds_read_b64_tr_b16 v[196:197], v223 offset:16384
    ds_read_b64_tr_b16 v[198:199], v223 offset:17408
    s_waitcnt lgkmcnt(2)
    v_mfma_f32_32x32x16_bf16 v[0:15], v[192:195], v[208:211], v[0:15]
    v_mfma_f32_32x32x16_bf16 v[16:31], v[192:195], v[212:215], v[16:31]
    v_mfma_f32_32x32x16_bf16 v[32:47], v[192:195], v[216:219], v[32:47]
    s_waitcnt lgkmcnt(0)
    v_mfma_f32_32x32x16_bf16 v[48:63], v[196:199], v[208:211], v[48:63]
    v_mfma_f32_32x32x16_bf16 v[64:79], v[196:199], v[212:215], v[64:79]
    v_mfma_f32_32x32x16_bf16 v[80:95], v[196:199], v[216:219], v[80:95]
    s_barrier
    ds_read_b64_tr_b16 v[192:193], v222 offset:0
    ds_read_b64_tr_b16 v[194:195], v222 offset:1024
    ds_read_b64_tr_b16 v[196:197], v223 offset:0
    ds_read_b64_tr_b16 v[198:199], v223 offset:1024
    s_waitcnt lgkmcnt(2)
    v_mfma_f32_32x32x16_bf16 v[96:111], v[192:195], v[208:211], v[96:111]
    v_mfma_f32_32x32x16_bf16 v[112:127], v[192:195], v[212:215], v[112:127]
    v_mfma_f32_32x32x16_bf16 v[128:143], v[192:195], v[216:219], v[128:143]
    s_waitcnt lgkmcnt(0)
    v_mfma_f32_32x32x16_bf16 v[144:159], v[196:199], v[208:211], v[144:159]
    v_mfma_f32_32x32x16_bf16 v[160:175], v[196:199], v[212:215], v[160:175]
    v_mfma_f32_32x32x16_bf16 v[176:191], v[196:199], v[216:219], v[176:191]
    s_barrier
    s_add_u32 s76, s75, 3
    s_and_b32 s76, s76, 7
    s_lshl_b32 s76, s76, 10
    v_add_u32 v234, s76, v226
    ds_read_b128 v[208:211], v234 offset:24576
    ds_read_b128 v[212:215], v234 offset:32768
    ds_read_b128 v[216:219], v234 offset:40960
    ds_read_b64_tr_b16 v[192:193], v222 offset:8192
    ds_read_b64_tr_b16 v[194:195], v222 offset:9216
    ds_read_b64_tr_b16 v[196:197], v223 offset:8192
    ds_read_b64_tr_b16 v[198:199], v223 offset:9216
    s_waitcnt lgkmcnt(2)
    v_mfma_f32_32x32x16_bf16 v[0:15], v[192:195], v[208:211], v[0:15]
    v_mfma_f32_32x32x16_bf16 v[16:31], v[192:195], v[212:215], v[16:31]
    v_mfma_f32_32x32x16_bf16 v[32:47], v[192:195], v[216:219], v[32:47]
    s_waitcnt lgkmcnt(0)
    v_mfma_f32_32x32x16_bf16 v[48:63], v[196:199], v[208:211], v[48:63]
    v_mfma_f32_32x32x16_bf16 v[64:79], v[196:199], v[212:215], v[64:79]
    v_mfma_f32_32x32x16_bf16 v[80:95], v[196:199], v[216:219], v[80:95]
    s_barrier
    ds_read_b64_tr_b16 v[192:193], v222 offset:16384
    ds_read_b64_tr_b16 v[194:195], v222 offset:17408
    ds_read_b64_tr_b16 v[196:197], v223 offset:16384
    ds_read_b64_tr_b16 v[198:199], v223 offset:17408
    s_waitcnt lgkmcnt(2)
    v_mfma_f32_32x32x16_bf16 v[96:111], v[192:195], v[208:211], v[96:111]
    v_mfma_f32_32x32x16_bf16 v[112:127], v[192:195], v[212:215], v[112:127]
    v_mfma_f32_32x32x16_bf16 v[128:143], v[192:195], v[216:219], v[128:143]
    s_waitcnt lgkmcnt(0)
    v_mfma_f32_32x32x16_bf16 v[144:159], v[196:199], v[208:211], v[144:159]
    v_mfma_f32_32x32x16_bf16 v[160:175], v[196:199], v[212:215], v[160:175]
    v_mfma_f32_32x32x16_bf16 v[176:191], v[196:199], v[216:219], v[176:191]
    s_barrier
    s_add_u32 s76, s75, 4
    s_and_b32 s76, s76, 7
    s_lshl_b32 s76, s76, 10
    v_add_u32 v234, s76, v226
    ds_read_b128 v[208:211], v234 offset:24576
    ds_read_b128 v[212:215], v234 offset:32768
    ds_read_b128 v[216:219], v234 offset:40960
    ds_read_b64_tr_b16 v[192:193], v222 offset:0
    ds_read_b64_tr_b16 v[194:195], v222 offset:1024
    ds_read_b64_tr_b16 v[196:197], v223 offset:0
    ds_read_b64_tr_b16 v[198:199], v223 offset:1024
    s_waitcnt lgkmcnt(2)
    v_mfma_f32_32x32x16_bf16 v[0:15], v[192:195], v[208:211], v[0:15]
    v_mfma_f32_32x32x16_bf16 v[16:31], v[192:195], v[212:215], v[16:31]
    v_mfma_f32_32x32x16_bf16 v[32:47], v[192:195], v[216:219], v[32:47]
    s_waitcnt lgkmcnt(0)
    v_mfma_f32_32x32x16_bf16 v[48:63], v[196:199], v[208:211], v[48:63]
    v_mfma_f32_32x32x16_bf16 v[64:79], v[196:199], v[212:215], v[64:79]
    v_mfma_f32_32x32x16_bf16 v[80:95], v[196:199], v[216:219], v[80:95]
    s_barrier
    ds_read_b64_tr_b16 v[192:193], v222 offset:8192
    ds_read_b64_tr_b16 v[194:195], v222 offset:9216
    ds_read_b64_tr_b16 v[196:197], v223 offset:8192
    ds_read_b64_tr_b16 v[198:199], v223 offset:9216
    s_waitcnt lgkmcnt(2)
    v_mfma_f32_32x32x16_bf16 v[96:111], v[192:195], v[208:211], v[96:111]
    v_mfma_f32_32x32x16_bf16 v[112:127], v[192:195], v[212:215], v[112:127]
    v_mfma_f32_32x32x16_bf16 v[128:143], v[192:195], v[216:219], v[128:143]
    s_waitcnt lgkmcnt(0)
    v_mfma_f32_32x32x16_bf16 v[144:159], v[196:199], v[208:211], v[144:159]
    v_mfma_f32_32x32x16_bf16 v[160:175], v[196:199], v[212:215], v[160:175]
    v_mfma_f32_32x32x16_bf16 v[176:191], v[196:199], v[216:219], v[176:191]
    s_barrier
    s_add_u32 s76, s75, 5
    s_and_b32 s76, s76, 7
    s_lshl_b32 s76, s76, 10
    v_add_u32 v234, s76, v226
    ds_read_b128 v[208:211], v234 offset:24576
    ds_read_b128 v[212:215], v234 offset:32768
    ds_read_b128 v[216:219], v234 offset:40960
    ds_read_b64_tr_b16 v[192:193], v222 offset:16384
    ds_read_b64_tr_b16 v[194:195], v222 offset:17408
    ds_read_b64_tr_b16 v[196:197], v223 offset:16384
    ds_read_b64_tr_b16 v[198:199], v223 offset:17408
    s_waitcnt lgkmcnt(2)
    v_mfma_f32_32x32x16_bf16 v[0:15], v[192:195], v[208:211], v[0:15]
    v_mfma_f32_32x32x16_bf16 v[16:31], v[192:195], v[212:215], v[16:31]
    v_mfma_f32_32x32x16_bf16 v[32:47], v[192:195], v[216:219], v[32:47]
    s_waitcnt lgkmcnt(0)
    v_mfma_f32_32x32x16_bf16 v[48:63], v[196:199], v[208:211], v[48:63]
    v_mfma_f32_32x32x16_bf16 v[64:79], v[196:199], v[212:215], v[64:79]
    v_mfma_f32_32x32x16_bf16 v[80:95], v[196:199], v[216:219], v[80:95]
    s_barrier
    ds_read_b64_tr_b16 v[192:193], v222 offset:0
    ds_read_b64_tr_b16 v[194:195], v222 offset:1024
    ds_read_b64_tr_b16 v[196:197], v223 offset:0
    ds_read_b64_tr_b16 v[198:199], v223 offset:1024
    s_waitcnt lgkmcnt(2)
    v_mfma_f32_32x32x16_bf16 v[96:111], v[192:195], v[208:211], v[96:111]
    v_mfma_f32_32x32x16_bf16 v[112:127], v[192:195], v[212:215], v[112:127]
    v_mfma_f32_32x32x16_bf16 v[128:143], v[192:195], v[216:219], v[128:143]
    s_waitcnt lgkmcnt(0)
    v_mfma_f32_32x32x16_bf16 v[144:159], v[196:199], v[208:211], v[144:159]
    v_mfma_f32_32x32x16_bf16 v[160:175], v[196:199], v[212:215], v[160:175]
    v_mfma_f32_32x32x16_bf16 v[176:191], v[196:199], v[216:219], v[176:191]
    s_barrier
    s_add_u32 s76, s75, 6
    s_and_b32 s76, s76, 7
    s_lshl_b32 s76, s76, 10
    v_add_u32 v234, s76, v226
    ds_read_b128 v[208:211], v234 offset:24576
    ds_read_b128 v[212:215], v234 offset:32768
    ds_read_b128 v[216:219], v234 offset:40960
    ds_read_b64_tr_b16 v[192:193], v222 offset:8192
    ds_read_b64_tr_b16 v[194:195], v222 offset:9216
    ds_read_b64_tr_b16 v[196:197], v223 offset:8192
    ds_read_b64_tr_b16 v[198:199], v223 offset:9216
    s_waitcnt lgkmcnt(2)
    v_mfma_f32_32x32x16_bf16 v[0:15], v[192:195], v[208:211], v[0:15]
    v_mfma_f32_32x32x16_bf16 v[16:31], v[192:195], v[212:215], v[16:31]
    v_mfma_f32_32x32x16_bf16 v[32:47], v[192:195], v[216:219], v[32:47]
    s_waitcnt lgkmcnt(0)
    v_mfma_f32_32x32x16_bf16 v[48:63], v[196:199], v[208:211], v[48:63]
    v_mfma_f32_32x32x16_bf16 v[64:79], v[196:199], v[212:215], v[64:79]
    v_mfma_f32_32x32x16_bf16 v[80:95], v[196:199], v[216:219], v[80:95]
    s_barrier
    ds_read_b64_tr_b16 v[192:193], v222 offset:16384
    ds_read_b64_tr_b16 v[194:195], v222 offset:17408
    ds_read_b64_tr_b16 v[196:197], v223 offset:16384
    ds_read_b64_tr_b16 v[198:199], v223 offset:17408
    s_waitcnt lgkmcnt(2)
    v_mfma_f32_32x32x16_bf16 v[96:111], v[192:195], v[208:211], v[96:111]
    v_mfma_f32_32x32x16_bf16 v[112:127], v[192:195], v[212:215], v[112:127]
    v_mfma_f32_32x32x16_bf16 v[128:143], v[192:195], v[216:219], v[128:143]
    s_waitcnt lgkmcnt(0)
    v_mfma_f32_32x32x16_bf16 v[144:159], v[196:199], v[208:211], v[144:159]
    v_mfma_f32_32x32x16_bf16 v[160:175], v[196:199], v[212:215], v[160:175]
    v_mfma_f32_32x32x16_bf16 v[176:191], v[196:199], v[216:219], v[176:191]
    s_barrier
    s_add_u32 s76, s75, 7
    s_and_b32 s76, s76, 7
    s_lshl_b32 s76, s76, 10
    v_add_u32 v234, s76, v226
    ds_read_b128 v[208:211], v234 offset:24576
    ds_read_b128 v[212:215], v234 offset:32768
    ds_read_b128 v[216:219], v234 offset:40960
    ds_read_b64_tr_b16 v[192:193], v222 offset:0
    ds_read_b64_tr_b16 v[194:195], v222 offset:1024
    ds_read_b64_tr_b16 v[196:197], v223 offset:0
    ds_read_b64_tr_b16 v[198:199], v223 offset:1024
    s_waitcnt lgkmcnt(2)
    v_mfma_f32_32x32x16_bf16 v[0:15], v[192:195], v[208:211], v[0:15]
    v_mfma_f32_32x32x16_bf16 v[16:31], v[192:195], v[212:215], v[16:31]
    v_mfma_f32_32x32x16_bf16 v[32:47], v[192:195], v[216:219], v[32:47]
    s_waitcnt lgkmcnt(0)
    v_mfma_f32_32x32x16_bf16 v[48:63], v[196:199], v[208:211], v[48:63]
    v_mfma_f32_32x32x16_bf16 v[64:79], v[196:199], v[212:215], v[64:79]
    v_mfma_f32_32x32x16_bf16 v[80:95], v[196:199], v[216:219], v[80:95]
    s_barrier
    ds_read_b64_tr_b16 v[192:193], v222 offset:8192
    ds_read_b64_tr_b16 v[194:195], v222 offset:9216
    ds_read_b64_tr_b16 v[196:197], v223 offset:8192
    ds_read_b64_tr_b16 v[198:199], v223 offset:9216
    s_waitcnt lgkmcnt(2)
    v_mfma_f32_32x32x16_bf16 v[96:111], v[192:195], v[208:211], v[96:111]
    v_mfma_f32_32x32x16_bf16 v[112:127], v[192:195], v[212:215], v[112:127]
    v_mfma_f32_32x32x16_bf16 v[128:143], v[192:195], v[216:219], v[128:143]
    s_waitcnt lgkmcnt(0)
    v_mfma_f32_32x32x16_bf16 v[144:159], v[196:199], v[208:211], v[144:159]
    v_mfma_f32_32x32x16_bf16 v[160:175], v[196:199], v[212:215], v[160:175]
    v_mfma_f32_32x32x16_bf16 v[176:191], v[196:199], v[216:219], v[176:191]
    s_barrier
    s_add_u32 s76, s75, 0
    s_and_b32 s76, s76, 7
    s_lshl_b32 s76, s76, 10
    v_add_u32 v234, s76, v227
    ds_read_b128 v[208:211], v234 offset:0
    ds_read_b128 v[212:215], v234 offset:8192
    ds_read_b128 v[216:219], v234 offset:16384
    ds_read_b64_tr_b16 v[192:193], v222 offset:16384
    ds_read_b64_tr_b16 v[194:195], v222 offset:17408
    ds_read_b64_tr_b16 v[196:197], v223 offset:16384
    ds_read_b64_tr_b16 v[198:199], v223 offset:17408
    s_waitcnt lgkmcnt(2)
    v_mfma_f32_32x32x16_bf16 v[0:15], v[192:195], v[208:211], v[0:15]
    v_mfma_f32_32x32x16_bf16 v[16:31], v[192:195], v[212:215], v[16:31]
    v_mfma_f32_32x32x16_bf16 v[32:47], v[192:195], v[216:219], v[32:47]
    s_waitcnt lgkmcnt(0)
    v_mfma_f32_32x32x16_bf16 v[48:63], v[196:199], v[208:211], v[48:63]
    v_mfma_f32_32x32x16_bf16 v[64:79], v[196:199], v[212:215], v[64:79]
    v_mfma_f32_32x32x16_bf16 v[80:95], v[196:199], v[216:219], v[80:95]
    s_barrier
    ds_read_b64_tr_b16 v[192:193], v222 offset:0
    ds_read_b64_tr_b16 v[194:195], v222 offset:1024
    ds_read_b64_tr_b16 v[196:197], v223 offset:0
    ds_read_b64_tr_b16 v[198:199], v223 offset:1024
    s_waitcnt lgkmcnt(2)
    v_mfma_f32_32x32x16_bf16 v[96:111], v[192:195], v[208:211], v[96:111]
    v_mfma_f32_32x32x16_bf16 v[112:127], v[192:195], v[212:215], v[112:127]
    v_mfma_f32_32x32x16_bf16 v[128:143], v[192:195], v[216:219], v[128:143]
    s_waitcnt lgkmcnt(0)
    v_mfma_f32_32x32x16_bf16 v[144:159], v[196:199], v[208:211], v[144:159]
    v_mfma_f32_32x32x16_bf16 v[160:175], v[196:199], v[212:215], v[160:175]
    v_mfma_f32_32x32x16_bf16 v[176:191], v[196:199], v[216:219], v[176:191]
    s_barrier
    s_add_u32 s76, s75, 1
    s_and_b32 s76, s76, 7
    s_lshl_b32 s76, s76, 10
    v_add_u32 v234, s76, v227
    ds_read_b128 v[208:211], v234 offset:0
    ds_read_b128 v[212:215], v234 offset:8192
    ds_read_b128 v[216:219], v234 offset:16384
    ds_read_b64_tr_b16 v[192:193], v222 offset:8192
    ds_read_b64_tr_b16 v[194:195], v222 offset:9216
    ds_read_b64_tr_b16 v[196:197], v223 offset:8192
    ds_read_b64_tr_b16 v[198:199], v223 offset:9216
    s_waitcnt lgkmcnt(2)
    v_mfma_f32_32x32x16_bf16 v[0:15], v[192:195], v[208:211], v[0:15]
    v_mfma_f32_32x32x16_bf16 v[16:31], v[192:195], v[212:215], v[16:31]
    v_mfma_f32_32x32x16_bf16 v[32:47], v[192:195], v[216:219], v[32:47]
    s_waitcnt lgkmcnt(0)
    v_mfma_f32_32x32x16_bf16 v[48:63], v[196:199], v[208:211], v[48:63]
    v_mfma_f32_32x32x16_bf16 v[64:79], v[196:199], v[212:215], v[64:79]
    v_mfma_f32_32x32x16_bf16 v[80:95], v[196:199], v[216:219], v[80:95]
    s_barrier
    ds_read_b64_tr_b16 v[192:193], v222 offset:16384
    ds_read_b64_tr_b16 v[194:195], v222 offset:17408
    ds_read_b64_tr_b16 v[196:197], v223 offset:16384
    ds_read_b64_tr_b16 v[198:199], v223 offset:17408
    s_waitcnt lgkmcnt(2)
    v_mfma_f32_32x32x16_bf16 v[96:111], v[192:195], v[208:211], v[96:111]
    v_mfma_f32_32x32x16_bf16 v[112:127], v[192:195], v[212:215], v[112:127]
    v_mfma_f32_32x32x16_bf16 v[128:143], v[192:195], v[216:219], v[128:143]
    s_waitcnt lgkmcnt(0)
    v_mfma_f32_32x32x16_bf16 v[144:159], v[196:199], v[208:211], v[144:159]
    v_mfma_f32_32x32x16_bf16 v[160:175], v[196:199], v[212:215], v[160:175]
    v_mfma_f32_32x32x16_bf16 v[176:191], v[196:199], v[216:219], v[176:191]
    s_barrier
    s_add_u32 s76, s75, 2
    s_and_b32 s76, s76, 7
    s_lshl_b32 s76, s76, 10
    v_add_u32 v234, s76, v227
    ds_read_b128 v[208:211], v234 offset:0
    ds_read_b128 v[212:215], v234 offset:8192
    ds_read_b128 v[216:219], v234 offset:16384
    ds_read_b64_tr_b16 v[192:193], v222 offset:0
    ds_read_b64_tr_b16 v[194:195], v222 offset:1024
    ds_read_b64_tr_b16 v[196:197], v223 offset:0
    ds_read_b64_tr_b16 v[198:199], v223 offset:1024
    s_waitcnt lgkmcnt(2)
    v_mfma_f32_32x32x16_bf16 v[0:15], v[192:195], v[208:211], v[0:15]
    v_mfma_f32_32x32x16_bf16 v[16:31], v[192:195], v[212:215], v[16:31]
    v_mfma_f32_32x32x16_bf16 v[32:47], v[192:195], v[216:219], v[32:47]
    s_waitcnt lgkmcnt(0)
    v_mfma_f32_32x32x16_bf16 v[48:63], v[196:199], v[208:211], v[48:63]
    v_mfma_f32_32x32x16_bf16 v[64:79], v[196:199], v[212:215], v[64:79]
    v_mfma_f32_32x32x16_bf16 v[80:95], v[196:199], v[216:219], v[80:95]
    s_barrier
    ds_read_b64_tr_b16 v[192:193], v222 offset:8192
    ds_read_b64_tr_b16 v[194:195], v222 offset:9216
    ds_read_b64_tr_b16 v[196:197], v223 offset:8192
    ds_read_b64_tr_b16 v[198:199], v223 offset:9216
    s_waitcnt lgkmcnt(2)
    v_mfma_f32_32x32x16_bf16 v[96:111], v[192:195], v[208:211], v[96:111]
    v_mfma_f32_32x32x16_bf16 v[112:127], v[192:195], v[212:215], v[112:127]
    v_mfma_f32_32x32x16_bf16 v[128:143], v[192:195], v[216:219], v[128:143]
    s_waitcnt lgkmcnt(0)
    v_mfma_f32_32x32x16_bf16 v[144:159], v[196:199], v[208:211], v[144:159]
    v_mfma_f32_32x32x16_bf16 v[160:175], v[196:199], v[212:215], v[160:175]
    v_mfma_f32_32x32x16_bf16 v[176:191], v[196:199], v[216:219], v[176:191]
    s_barrier
    s_add_u32 s76, s75, 3
    s_and_b32 s76, s76, 7
    s_lshl_b32 s76, s76, 10
    v_add_u32 v234, s76, v227
    ds_read_b128 v[208:211], v234 offset:0
    ds_read_b128 v[212:215], v234 offset:8192
    ds_read_b128 v[216:219], v234 offset:16384
    ds_read_b64_tr_b16 v[192:193], v222 offset:16384
    ds_read_b64_tr_b16 v[194:195], v222 offset:17408
    ds_read_b64_tr_b16 v[196:197], v223 offset:16384
    ds_read_b64_tr_b16 v[198:199], v223 offset:17408
    s_waitcnt lgkmcnt(2)
    v_mfma_f32_32x32x16_bf16 v[0:15], v[192:195], v[208:211], v[0:15]
    v_mfma_f32_32x32x16_bf16 v[16:31], v[192:195], v[212:215], v[16:31]
    v_mfma_f32_32x32x16_bf16 v[32:47], v[192:195], v[216:219], v[32:47]
    s_waitcnt lgkmcnt(0)
    v_mfma_f32_32x32x16_bf16 v[48:63], v[196:199], v[208:211], v[48:63]
    v_mfma_f32_32x32x16_bf16 v[64:79], v[196:199], v[212:215], v[64:79]
    v_mfma_f32_32x32x16_bf16 v[80:95], v[196:199], v[216:219], v[80:95]
    s_barrier
    ds_read_b64_tr_b16 v[192:193], v222 offset:0
    ds_read_b64_tr_b16 v[194:195], v222 offset:1024
    ds_read_b64_tr_b16 v[196:197], v223 offset:0
    ds_read_b64_tr_b16 v[198:199], v223 offset:1024
    s_waitcnt lgkmcnt(2)
    v_mfma_f32_32x32x16_bf16 v[96:111], v[192:195], v[208:211], v[96:111]
    v_mfma_f32_32x32x16_bf16 v[112:127], v[192:195], v[212:215], v[112:127]
    v_mfma_f32_32x32x16_bf16 v[128:143], v[192:195], v[216:219], v[128:143]
    s_waitcnt lgkmcnt(0)
    v_mfma_f32_32x32x16_bf16 v[144:159], v[196:199], v[208:211], v[144:159]
    v_mfma_f32_32x32x16_bf16 v[160:175], v[196:199], v[212:215], v[160:175]
    v_mfma_f32_32x32x16_bf16 v[176:191], v[196:199], v[216:219], v[176:191]
    s_barrier
    s_add_u32 s76, s75, 4
    s_and_b32 s76, s76, 7
    s_lshl_b32 s76, s76, 10
    v_add_u32 v234, s76, v227
    ds_read_b128 v[208:211], v234 offset:0
    ds_read_b128 v[212:215], v234 offset:8192
    ds_read_b128 v[216:219], v234 offset:16384
    ds_read_b64_tr_b16 v[192:193], v222 offset:8192
    ds_read_b64_tr_b16 v[194:195], v222 offset:9216
    ds_read_b64_tr_b16 v[196:197], v223 offset:8192
    ds_read_b64_tr_b16 v[198:199], v223 offset:9216
    s_waitcnt lgkmcnt(2)
    v_mfma_f32_32x32x16_bf16 v[0:15], v[192:195], v[208:211], v[0:15]
    v_mfma_f32_32x32x16_bf16 v[16:31], v[192:195], v[212:215], v[16:31]
    v_mfma_f32_32x32x16_bf16 v[32:47], v[192:195], v[216:219], v[32:47]
    s_waitcnt lgkmcnt(0)
    v_mfma_f32_32x32x16_bf16 v[48:63], v[196:199], v[208:211], v[48:63]
    v_mfma_f32_32x32x16_bf16 v[64:79], v[196:199], v[212:215], v[64:79]
    v_mfma_f32_32x32x16_bf16 v[80:95], v[196:199], v[216:219], v[80:95]
    s_barrier
    ds_read_b64_tr_b16 v[192:193], v222 offset:16384
    ds_read_b64_tr_b16 v[194:195], v222 offset:17408
    ds_read_b64_tr_b16 v[196:197], v223 offset:16384
    ds_read_b64_tr_b16 v[198:199], v223 offset:17408
    s_waitcnt lgkmcnt(2)
    v_mfma_f32_32x32x16_bf16 v[96:111], v[192:195], v[208:211], v[96:111]
    v_mfma_f32_32x32x16_bf16 v[112:127], v[192:195], v[212:215], v[112:127]
    v_mfma_f32_32x32x16_bf16 v[128:143], v[192:195], v[216:219], v[128:143]
    s_waitcnt lgkmcnt(0)
    v_mfma_f32_32x32x16_bf16 v[144:159], v[196:199], v[208:211], v[144:159]
    v_mfma_f32_32x32x16_bf16 v[160:175], v[196:199], v[212:215], v[160:175]
    v_mfma_f32_32x32x16_bf16 v[176:191], v[196:199], v[216:219], v[176:191]
    s_barrier
    s_add_u32 s76, s75, 5
    s_and_b32 s76, s76, 7
    s_lshl_b32 s76, s76, 10
    v_add_u32 v234, s76, v227
    ds_read_b128 v[208:211], v234 offset:0
    ds_read_b128 v[212:215], v234 offset:8192
    ds_read_b128 v[216:219], v234 offset:16384
    ds_read_b64_tr_b16 v[192:193], v222 offset:0
    ds_read_b64_tr_b16 v[194:195], v222 offset:1024
    ds_read_b64_tr_b16 v[196:197], v223 offset:0
    ds_read_b64_tr_b16 v[198:199], v223 offset:1024
    s_waitcnt lgkmcnt(2)
    v_mfma_f32_32x32x16_bf16 v[0:15], v[192:195], v[208:211], v[0:15]
    v_mfma_f32_32x32x16_bf16 v[16:31], v[192:195], v[212:215], v[16:31]
    v_mfma_f32_32x32x16_bf16 v[32:47], v[192:195], v[216:219], v[32:47]
    s_waitcnt lgkmcnt(0)
    v_mfma_f32_32x32x16_bf16 v[48:63], v[196:199], v[208:211], v[48:63]
    v_mfma_f32_32x32x16_bf16 v[64:79], v[196:199], v[212:215], v[64:79]
    v_mfma_f32_32x32x16_bf16 v[80:95], v[196:199], v[216:219], v[80:95]
    ds_read_b64_tr_b16 v[192:193], v222 offset:49152
    ds_read_b64_tr_b16 v[194:195], v222 offset:50176
    ds_read_b64_tr_b16 v[196:197], v223 offset:49152
    ds_read_b64_tr_b16 v[198:199], v223 offset:50176
    s_waitcnt lgkmcnt(2)
    v_mfma_f32_32x32x16_bf16 v[96:111], v[192:195], v[208:211], v[96:111]
    v_mfma_f32_32x32x16_bf16 v[112:127], v[192:195], v[212:215], v[112:127]
    v_mfma_f32_32x32x16_bf16 v[128:143], v[192:195], v[216:219], v[128:143]
    s_waitcnt lgkmcnt(0)
    v_mfma_f32_32x32x16_bf16 v[144:159], v[196:199], v[208:211], v[144:159]
    v_mfma_f32_32x32x16_bf16 v[160:175], v[196:199], v[212:215], v[160:175]
    v_mfma_f32_32x32x16_bf16 v[176:191], v[196:199], v[216:219], v[176:191]
    s_barrier
    s_add_u32 s76, s75, 6
    s_and_b32 s76, s76, 7
    s_lshl_b32 s76, s76, 10
    v_add_u32 v234, s76, v227
    ds_read_b128 v[208:211], v234 offset:0
    ds_read_b128 v[212:215], v234 offset:8192
    ds_read_b128 v[216:219], v234 offset:16384
    ds_read_b64_tr_b16 v[192:193], v222 offset:8192
    ds_read_b64_tr_b16 v[194:195], v222 offset:9216
    ds_read_b64_tr_b16 v[196:197], v223 offset:8192
    ds_read_b64_tr_b16 v[198:199], v223 offset:9216
    s_waitcnt lgkmcnt(2)
    v_mfma_f32_32x32x16_bf16 v[0:15], v[192:195], v[208:211], v[0:15]
    v_mfma_f32_32x32x16_bf16 v[16:31], v[192:195], v[212:215], v[16:31]
    v_mfma_f32_32x32x16_bf16 v[32:47], v[192:195], v[216:219], v[32:47]
    s_waitcnt lgkmcnt(0)
    v_mfma_f32_32x32x16_bf16 v[48:63], v[196:199], v[208:211], v[48:63]
    v_mfma_f32_32x32x16_bf16 v[64:79], v[196:199], v[212:215], v[64:79]
    v_mfma_f32_32x32x16_bf16 v[80:95], v[196:199], v[216:219], v[80:95]
    ds_read_b64_tr_b16 v[192:193], v220 offset:0
    ds_read_b64_tr_b16 v[194:195], v220 offset:1024
    ds_read_b64_tr_b16 v[196:197], v221 offset:0
    ds_read_b64_tr_b16 v[198:199], v221 offset:1024
    s_waitcnt lgkmcnt(2)
    v_mfma_f32_32x32x16_bf16 v[96:111], v[192:195], v[208:211], v[96:111]
    v_mfma_f32_32x32x16_bf16 v[112:127], v[192:195], v[212:215], v[112:127]
    v_mfma_f32_32x32x16_bf16 v[128:143], v[192:195], v[216:219], v[128:143]
    s_waitcnt lgkmcnt(0)
    v_mfma_f32_32x32x16_bf16 v[144:159], v[196:199], v[208:211], v[144:159]
    v_mfma_f32_32x32x16_bf16 v[160:175], v[196:199], v[212:215], v[160:175]
    v_mfma_f32_32x32x16_bf16 v[176:191], v[196:199], v[216:219], v[176:191]
    s_barrier
    s_add_u32 s76, s75, 7
    s_and_b32 s76, s76, 7
    s_lshl_b32 s76, s76, 10
    v_add_u32 v234, s76, v227
    ds_read_b128 v[208:211], v234 offset:0
    ds_read_b128 v[212:215], v234 offset:8192
    ds_read_b128 v[216:219], v234 offset:16384
    ds_read_b64_tr_b16 v[192:193], v222 offset:16384
    ds_read_b64_tr_b16 v[194:195], v222 offset:17408
    ds_read_b64_tr_b16 v[196:197], v223 offset:16384
    ds_read_b64_tr_b16 v[198:199], v223 offset:17408
    s_waitcnt lgkmcnt(2)
    v_mfma_f32_32x32x16_bf16 v[0:15], v[192:195], v[208:211], v[0:15]
    v_mfma_f32_32x32x16_bf16 v[16:31], v[192:195], v[212:215], v[16:31]
    v_mfma_f32_32x32x16_bf16 v[32:47], v[192:195], v[216:219], v[32:47]
    s_waitcnt lgkmcnt(0)
    v_mfma_f32_32x32x16_bf16 v[48:63], v[196:199], v[208:211], v[48:63]
    v_mfma_f32_32x32x16_bf16 v[64:79], v[196:199], v[212:215], v[64:79]
    v_mfma_f32_32x32x16_bf16 v[80:95], v[196:199], v[216:219], v[80:95]
    ds_read_b64_tr_b16 v[192:193], v220 offset:8192
    ds_read_b64_tr_b16 v[194:195], v220 offset:9216
    ds_read_b64_tr_b16 v[196:197], v221 offset:8192
    ds_read_b64_tr_b16 v[198:199], v221 offset:9216
    s_waitcnt lgkmcnt(2)
    v_mfma_f32_32x32x16_bf16 v[96:111], v[192:195], v[208:211], v[96:111]
    v_mfma_f32_32x32x16_bf16 v[112:127], v[192:195], v[212:215], v[112:127]
    v_mfma_f32_32x32x16_bf16 v[128:143], v[192:195], v[216:219], v[128:143]
    s_waitcnt lgkmcnt(0)
    v_mfma_f32_32x32x16_bf16 v[144:159], v[196:199], v[208:211], v[144:159]
    v_mfma_f32_32x32x16_bf16 v[160:175], v[196:199], v[212:215], v[160:175]
    v_mfma_f32_32x32x16_bf16 v[176:191], v[196:199], v[216:219], v[176:191]
    s_barrier
    s_barrier
    s_add_u32 s76, s75, 0
    s_and_b32 s76, s76, 7
    s_lshl_b32 s76, s76, 10
    v_add_u32 v234, s76, v226
    ds_read_b128 v[200:203], v234 offset:0
    ds_read_b128 v[204:207], v234 offset:8192
    ds_read_b128 v[208:211], v234 offset:16384
    ds_read_b64_tr_b16 v[192:193], v222 offset:57344
    ds_read_b64_tr_b16 v[194:195], v222 offset:58368
    ds_read_b64_tr_b16 v[196:197], v223 offset:57344
    ds_read_b64_tr_b16 v[198:199], v223 offset:58368
    s_add_u32 s76, s75, 1
    s_and_b32 s76, s76, 7
    s_lshl_b32 s76, s76, 10
    v_add_u32 v234, s76, v226
    ds_read_b128 v[238:241], v234 offset:0
    ds_read_b128 v[242:245], v234 offset:8192
    ds_read_b128 v[246:249], v234 offset:16384
    ds_read_b64_tr_b16 v[212:213], v224 offset:0
    ds_read_b64_tr_b16 v[214:215], v224 offset:1024
    ds_read_b64_tr_b16 v[216:217], v225 offset:0
    ds_read_b64_tr_b16 v[218:219], v225 offset:1024
    s_waitcnt lgkmcnt(9)
    v_mfma_f32_32x32x16_bf16 v[0:15], v[192:195], v[200:203], v[0:15]
    v_mfma_f32_32x32x16_bf16 v[16:31], v[192:195], v[204:207], v[16:31]
    v_mfma_f32_32x32x16_bf16 v[32:47], v[192:195], v[208:211], v[32:47]
    s_waitcnt lgkmcnt(7)
    v_mfma_f32_32x32x16_bf16 v[48:63], v[196:199], v[200:203], v[48:63]
    v_mfma_f32_32x32x16_bf16 v[64:79], v[196:199], v[204:207], v[64:79]
    v_mfma_f32_32x32x16_bf16 v[80:95], v[196:199], v[208:211], v[80:95]
    s_add_u32 s76, s75, 2
    s_and_b32 s76, s76, 7
    s_lshl_b32 s76, s76, 10
    v_add_u32 v234, s76, v226
    ds_read_b128 v[200:203], v234 offset:0
    ds_read_b128 v[204:207], v234 offset:8192
    ds_read_b128 v[208:211], v234 offset:16384
    ds_read_b64_tr_b16 v[192:193], v220 offset:32768
    ds_read_b64_tr_b16 v[194:195], v220 offset:33792
    ds_read_b64_tr_b16 v[196:197], v221 offset:32768
    ds_read_b64_tr_b16 v[198:199], v221 offset:33792
    s_waitcnt lgkmcnt(9)
    v_mfma_f32_32x32x16_bf16 v[0:15], v[212:215], v[238:241], v[0:15]
    v_mfma_f32_32x32x16_bf16 v[16:31], v[212:215], v[242:245], v[16:31]
    v_mfma_f32_32x32x16_bf16 v[32:47], v[212:215], v[246:249], v[32:47]
    s_waitcnt lgkmcnt(7)
    v_mfma_f32_32x32x16_bf16 v[48:63], v[216:219], v[238:241], v[48:63]
    v_mfma_f32_32x32x16_bf16 v[64:79], v[216:219], v[242:245], v[64:79]
    v_mfma_f32_32x32x16_bf16 v[80:95], v[216:219], v[246:249], v[80:95]
    s_add_u32 s76, s75, 3
    s_and_b32 s76, s76, 7
    s_lshl_b32 s76, s76, 10
    v_add_u32 v234, s76, v226
    ds_read_b128 v[238:241], v234 offset:0
    ds_read_b128 v[242:245], v234 offset:8192
    ds_read_b128 v[246:249], v234 offset:16384
    ds_read_b64_tr_b16 v[212:213], v222 offset:0
    ds_read_b64_tr_b16 v[214:215], v222 offset:1024
    ds_read_b64_tr_b16 v[216:217], v223 offset:0
    ds_read_b64_tr_b16 v[218:219], v223 offset:1024
    s_waitcnt lgkmcnt(9)
    v_mfma_f32_32x32x16_bf16 v[0:15], v[192:195], v[200:203], v[0:15]
    v_mfma_f32_32x32x16_bf16 v[16:31], v[192:195], v[204:207], v[16:31]
    v_mfma_f32_32x32x16_bf16 v[32:47], v[192:195], v[208:211], v[32:47]
    s_waitcnt lgkmcnt(7)
    v_mfma_f32_32x32x16_bf16 v[48:63], v[196:199], v[200:203], v[48:63]
    v_mfma_f32_32x32x16_bf16 v[64:79], v[196:199], v[204:207], v[64:79]
    v_mfma_f32_32x32x16_bf16 v[80:95], v[196:199], v[208:211], v[80:95]
    s_add_u32 s76, s75, 4
    s_and_b32 s76, s76, 7
    s_lshl_b32 s76, s76, 10
    v_add_u32 v234, s76, v226
    ds_read_b128 v[200:203], v234 offset:0
    ds_read_b128 v[204:207], v234 offset:8192
    ds_read_b128 v[208:211], v234 offset:16384
    ds_read_b64_tr_b16 v[192:193], v222 offset:49152
    ds_read_b64_tr_b16 v[194:195], v222 offset:50176
    ds_read_b64_tr_b16 v[196:197], v223 offset:49152
    ds_read_b64_tr_b16 v[198:199], v223 offset:50176
    s_waitcnt lgkmcnt(9)
    v_mfma_f32_32x32x16_bf16 v[0:15], v[212:215], v[238:241], v[0:15]
    v_mfma_f32_32x32x16_bf16 v[16:31], v[212:215], v[242:245], v[16:31]
    v_mfma_f32_32x32x16_bf16 v[32:47], v[212:215], v[246:249], v[32:47]
    s_waitcnt lgkmcnt(7)
    v_mfma_f32_32x32x16_bf16 v[48:63], v[216:219], v[238:241], v[48:63]
    v_mfma_f32_32x32x16_bf16 v[64:79], v[216:219], v[242:245], v[64:79]
    v_mfma_f32_32x32x16_bf16 v[80:95], v[216:219], v[246:249], v[80:95]
    s_add_u32 s76, s75, 5
    s_and_b32 s76, s76, 7
    s_lshl_b32 s76, s76, 10
    v_add_u32 v234, s76, v226
    ds_read_b128 v[238:241], v234 offset:0
    ds_read_b128 v[242:245], v234 offset:8192
    ds_read_b128 v[246:249], v234 offset:16384
    ds_read_b64_tr_b16 v[212:213], v220 offset:16384
    ds_read_b64_tr_b16 v[214:215], v220 offset:17408
    ds_read_b64_tr_b16 v[216:217], v221 offset:16384
    ds_read_b64_tr_b16 v[218:219], v221 offset:17408
    s_waitcnt lgkmcnt(9)
    v_mfma_f32_32x32x16_bf16 v[0:15], v[192:195], v[200:203], v[0:15]
    v_mfma_f32_32x32x16_bf16 v[16:31], v[192:195], v[204:207], v[16:31]
    v_mfma_f32_32x32x16_bf16 v[32:47], v[192:195], v[208:211], v[32:47]
    s_waitcnt lgkmcnt(7)
    v_mfma_f32_32x32x16_bf16 v[48:63], v[196:199], v[200:203], v[48:63]
    v_mfma_f32_32x32x16_bf16 v[64:79], v[196:199], v[204:207], v[64:79]
    v_mfma_f32_32x32x16_bf16 v[80:95], v[196:199], v[208:211], v[80:95]
    s_add_u32 s76, s75, 6
    s_and_b32 s76, s76, 7
    s_lshl_b32 s76, s76, 10
    v_add_u32 v234, s76, v226
    ds_read_b128 v[200:203], v234 offset:0
    ds_read_b128 v[204:207], v234 offset:8192
    ds_read_b128 v[208:211], v234 offset:16384
    ds_read_b64_tr_b16 v[192:193], v220 offset:40960
    ds_read_b64_tr_b16 v[194:195], v220 offset:41984
    ds_read_b64_tr_b16 v[196:197], v221 offset:40960
    ds_read_b64_tr_b16 v[198:199], v221 offset:41984
    s_waitcnt lgkmcnt(9)
    v_mfma_f32_32x32x16_bf16 v[0:15], v[212:215], v[238:241], v[0:15]
    v_mfma_f32_32x32x16_bf16 v[16:31], v[212:215], v[242:245], v[16:31]
    v_mfma_f32_32x32x16_bf16 v[32:47], v[212:215], v[246:249], v[32:47]
    s_waitcnt lgkmcnt(7)
    v_mfma_f32_32x32x16_bf16 v[48:63], v[216:219], v[238:241], v[48:63]
    v_mfma_f32_32x32x16_bf16 v[64:79], v[216:219], v[242:245], v[64:79]
    v_mfma_f32_32x32x16_bf16 v[80:95], v[216:219], v[246:249], v[80:95]
    s_add_u32 s76, s75, 7
    s_and_b32 s76, s76, 7
    s_lshl_b32 s76, s76, 10
    v_add_u32 v234, s76, v226
    ds_read_b128 v[238:241], v234 offset:0
    ds_read_b128 v[242:245], v234 offset:8192
    ds_read_b128 v[246:249], v234 offset:16384
    ds_read_b64_tr_b16 v[212:213], v222 offset:8192
    ds_read_b64_tr_b16 v[214:215], v222 offset:9216
    ds_read_b64_tr_b16 v[216:217], v223 offset:8192
    ds_read_b64_tr_b16 v[218:219], v223 offset:9216
    s_waitcnt lgkmcnt(9)
    v_mfma_f32_32x32x16_bf16 v[0:15], v[192:195], v[200:203], v[0:15]
    v_mfma_f32_32x32x16_bf16 v[16:31], v[192:195], v[204:207], v[16:31]
    v_mfma_f32_32x32x16_bf16 v[32:47], v[192:195], v[208:211], v[32:47]
    s_waitcnt lgkmcnt(7)
    v_mfma_f32_32x32x16_bf16 v[48:63], v[196:199], v[200:203], v[48:63]
    v_mfma_f32_32x32x16_bf16 v[64:79], v[196:199], v[204:207], v[64:79]
    v_mfma_f32_32x32x16_bf16 v[80:95], v[196:199], v[208:211], v[80:95]
    s_add_u32 s76, s75, 0
    s_and_b32 s76, s76, 7
    s_lshl_b32 s76, s76, 10
    v_add_u32 v234, s76, v226
    ds_read_b128 v[200:203], v234 offset:0
    ds_read_b128 v[204:207], v234 offset:8192
    ds_read_b128 v[208:211], v234 offset:16384
    ds_read_b64_tr_b16 v[192:193], v220 offset:0
    ds_read_b64_tr_b16 v[194:195], v220 offset:1024
    ds_read_b64_tr_b16 v[196:197], v221 offset:0
    ds_read_b64_tr_b16 v[198:199], v221 offset:1024
    s_waitcnt lgkmcnt(9)
    v_mfma_f32_32x32x16_bf16 v[0:15], v[212:215], v[238:241], v[0:15]
    v_mfma_f32_32x32x16_bf16 v[16:31], v[212:215], v[242:245], v[16:31]
    v_mfma_f32_32x32x16_bf16 v[32:47], v[212:215], v[246:249], v[32:47]
    s_waitcnt lgkmcnt(7)
    v_mfma_f32_32x32x16_bf16 v[48:63], v[216:219], v[238:241], v[48:63]
    v_mfma_f32_32x32x16_bf16 v[64:79], v[216:219], v[242:245], v[64:79]
    v_mfma_f32_32x32x16_bf16 v[80:95], v[216:219], v[246:249], v[80:95]
    s_add_u32 s76, s75, 1
    s_and_b32 s76, s76, 7
    s_lshl_b32 s76, s76, 10
    v_add_u32 v234, s76, v226
    ds_read_b128 v[238:241], v234 offset:0
    ds_read_b128 v[242:245], v234 offset:8192
    ds_read_b128 v[246:249], v234 offset:16384
    ds_read_b64_tr_b16 v[212:213], v220 offset:24576
    ds_read_b64_tr_b16 v[214:215], v220 offset:25600
    ds_read_b64_tr_b16 v[216:217], v221 offset:24576
    ds_read_b64_tr_b16 v[218:219], v221 offset:25600
    s_waitcnt lgkmcnt(9)
    v_mfma_f32_32x32x16_bf16 v[96:111], v[192:195], v[200:203], v[96:111]
    v_mfma_f32_32x32x16_bf16 v[112:127], v[192:195], v[204:207], v[112:127]
    v_mfma_f32_32x32x16_bf16 v[128:143], v[192:195], v[208:211], v[128:143]
    s_waitcnt lgkmcnt(7)
    v_mfma_f32_32x32x16_bf16 v[144:159], v[196:199], v[200:203], v[144:159]
    v_mfma_f32_32x32x16_bf16 v[160:175], v[196:199], v[204:207], v[160:175]
    v_mfma_f32_32x32x16_bf16 v[176:191], v[196:199], v[208:211], v[176:191]
    s_add_u32 s76, s75, 2
    s_and_b32 s76, s76, 7
    s_lshl_b32 s76, s76, 10
    v_add_u32 v234, s76, v226
    ds_read_b128 v[200:203], v234 offset:0
    ds_read_b128 v[204:207], v234 offset:8192
    ds_read_b128 v[208:211], v234 offset:16384
    ds_read_b64_tr_b16 v[192:193], v220 offset:49152
    ds_read_b64_tr_b16 v[194:195], v220 offset:50176
    ds_read_b64_tr_b16 v[196:197], v221 offset:49152
    ds_read_b64_tr_b16 v[198:199], v221 offset:50176
    s_waitcnt lgkmcnt(9)
    v_mfma_f32_32x32x16_bf16 v[96:111], v[212:215], v[238:241], v[96:111]
    v_mfma_f32_32x32x16_bf16 v[112:127], v[212:215], v[242:245], v[112:127]
    v_mfma_f32_32x32x16_bf16 v[128:143], v[212:215], v[246:249], v[128:143]
    s_waitcnt lgkmcnt(7)
    v_mfma_f32_32x32x16_bf16 v[144:159], v[216:219], v[238:241], v[144:159]
    v_mfma_f32_32x32x16_bf16 v[160:175], v[216:219], v[242:245], v[160:175]
    v_mfma_f32_32x32x16_bf16 v[176:191], v[216:219], v[246:249], v[176:191]
    v_cvt_pk_bf16_f32 v0, v0, v1
    v_cvt_pk_bf16_f32 v1, v2, v3
    v_cvt_pk_bf16_f32 v2, v4, v5
    v_cvt_pk_bf16_f32 v3, v6, v7
    v_cvt_pk_bf16_f32 v4, v8, v9
    v_cvt_pk_bf16_f32 v5, v10, v11
    v_cvt_pk_bf16_f32 v6, v12, v13
    v_cvt_pk_bf16_f32 v7, v14, v15
    s_mov_b32 s74, 0
    buffer_store_dwordx4 v[0:3], v236, s[56:59], s74 offen offset:0 sc1
    buffer_store_dwordx4 v[4:7], v236, s[56:59], s74 offen offset:1024 sc1
    v_cvt_pk_bf16_f32 v16, v16, v17
    v_cvt_pk_bf16_f32 v17, v18, v19
    v_cvt_pk_bf16_f32 v18, v20, v21
    v_cvt_pk_bf16_f32 v19, v22, v23
    v_cvt_pk_bf16_f32 v20, v24, v25
    v_cvt_pk_bf16_f32 v21, v26, v27
    v_cvt_pk_bf16_f32 v22, v28, v29
    v_cvt_pk_bf16_f32 v23, v30, v31
    s_mov_b32 s74, 2048
    buffer_store_dwordx4 v[16:19], v236, s[56:59], s74 offen offset:0 sc1
    buffer_store_dwordx4 v[20:23], v236, s[56:59], s74 offen offset:1024 sc1
    v_cvt_pk_bf16_f32 v32, v32, v33
    v_cvt_pk_bf16_f32 v33, v34, v35
    v_cvt_pk_bf16_f32 v34, v36, v37
    v_cvt_pk_bf16_f32 v35, v38, v39
    v_cvt_pk_bf16_f32 v36, v40, v41
    v_cvt_pk_bf16_f32 v37, v42, v43
    v_cvt_pk_bf16_f32 v38, v44, v45
    v_cvt_pk_bf16_f32 v39, v46, v47
    s_mov_b32 s74, 4096
    buffer_store_dwordx4 v[32:35], v236, s[56:59], s74 offen offset:0 sc1
    buffer_store_dwordx4 v[36:39], v236, s[56:59], s74 offen offset:1024 sc1
    v_cvt_pk_bf16_f32 v48, v48, v49
    v_cvt_pk_bf16_f32 v49, v50, v51
    v_cvt_pk_bf16_f32 v50, v52, v53
    v_cvt_pk_bf16_f32 v51, v54, v55
    v_cvt_pk_bf16_f32 v52, v56, v57
    v_cvt_pk_bf16_f32 v53, v58, v59
    v_cvt_pk_bf16_f32 v54, v60, v61
    v_cvt_pk_bf16_f32 v55, v62, v63
    s_mov_b32 s74, 6144
    buffer_store_dwordx4 v[48:51], v236, s[56:59], s74 offen offset:0 sc1
    buffer_store_dwordx4 v[52:55], v236, s[56:59], s74 offen offset:1024 sc1
    v_cvt_pk_bf16_f32 v64, v64, v65
    v_cvt_pk_bf16_f32 v65, v66, v67
    v_cvt_pk_bf16_f32 v66, v68, v69
    v_cvt_pk_bf16_f32 v67, v70, v71
    v_cvt_pk_bf16_f32 v68, v72, v73
    v_cvt_pk_bf16_f32 v69, v74, v75
    v_cvt_pk_bf16_f32 v70, v76, v77
    v_cvt_pk_bf16_f32 v71, v78, v79
    s_mov_b32 s74, 8192
    buffer_store_dwordx4 v[64:67], v236, s[56:59], s74 offen offset:0 sc1
    buffer_store_dwordx4 v[68:71], v236, s[56:59], s74 offen offset:1024 sc1
    v_cvt_pk_bf16_f32 v80, v80, v81
    v_cvt_pk_bf16_f32 v81, v82, v83
    v_cvt_pk_bf16_f32 v82, v84, v85
    v_cvt_pk_bf16_f32 v83, v86, v87
    v_cvt_pk_bf16_f32 v84, v88, v89
    v_cvt_pk_bf16_f32 v85, v90, v91
    v_cvt_pk_bf16_f32 v86, v92, v93
    v_cvt_pk_bf16_f32 v87, v94, v95
    s_mov_b32 s74, 10240
    buffer_store_dwordx4 v[80:83], v236, s[56:59], s74 offen offset:0 sc1
    buffer_store_dwordx4 v[84:87], v236, s[56:59], s74 offen offset:1024 sc1
    s_waitcnt lgkmcnt(2)
    v_mfma_f32_32x32x16_bf16 v[96:111], v[192:195], v[200:203], v[96:111]
    v_mfma_f32_32x32x16_bf16 v[112:127], v[192:195], v[204:207], v[112:127]
    v_mfma_f32_32x32x16_bf16 v[128:143], v[192:195], v[208:211], v[128:143]
    s_waitcnt lgkmcnt(0)
    v_mfma_f32_32x32x16_bf16 v[144:159], v[196:199], v[200:203], v[144:159]
    v_mfma_f32_32x32x16_bf16 v[160:175], v[196:199], v[204:207], v[160:175]
    v_mfma_f32_32x32x16_bf16 v[176:191], v[196:199], v[208:211], v[176:191]
    s_barrier
    s_add_u32 s76, s75, 3
    s_and_b32 s76, s76, 7
    s_lshl_b32 s76, s76, 10
    v_add_u32 v234, s76, v226
    ds_read_b128 v[200:203], v234 offset:0
    ds_read_b128 v[204:207], v234 offset:8192
    ds_read_b128 v[208:211], v234 offset:16384
    ds_read_b64_tr_b16 v[192:193], v222 offset:16384
    ds_read_b64_tr_b16 v[194:195], v222 offset:17408
    ds_read_b64_tr_b16 v[196:197], v223 offset:16384
    ds_read_b64_tr_b16 v[198:199], v223 offset:17408
    s_add_u32 s76, s75, 4
    s_and_b32 s76, s76, 7
    s_lshl_b32 s76, s76, 10
    v_add_u32 v234, s76, v226
    ds_read_b128 v[238:241], v234 offset:0
    ds_read_b128 v[242:245], v234 offset:8192
    ds_read_b128 v[246:249], v234 offset:16384
    ds_read_b64_tr_b16 v[212:213], v220 offset:8192
    ds_read_b64_tr_b16 v[214:215], v220 offset:9216
    ds_read_b64_tr_b16 v[216:217], v221 offset:8192
    ds_read_b64_tr_b16 v[218:219], v221 offset:9216
    s_waitcnt lgkmcnt(9)
    v_mfma_f32_32x32x16_bf16 v[96:111], v[192:195], v[200:203], v[96:111]
    v_mfma_f32_32x32x16_bf16 v[112:127], v[192:195], v[204:207], v[112:127]
    v_mfma_f32_32x32x16_bf16 v[128:143], v[192:195], v[208:211], v[128:143]
    s_waitcnt lgkmcnt(7)
    v_mfma_f32_32x32x16_bf16 v[144:159], v[196:199], v[200:203], v[144:159]
    v_mfma_f32_32x32x16_bf16 v[160:175], v[196:199], v[204:207], v[160:175]
    v_mfma_f32_32x32x16_bf16 v[176:191], v[196:199], v[208:211], v[176:191]
    s_add_u32 s76, s75, 5
    s_and_b32 s76, s76, 7
    s_lshl_b32 s76, s76, 10
    v_add_u32 v234, s76, v226
    ds_read_b128 v[200:203], v234 offset:0
    ds_read_b128 v[204:207], v234 offset:8192
    ds_read_b128 v[208:211], v234 offset:16384
    ds_read_b64_tr_b16 v[192:193], v220 offset:57344
    ds_read_b64_tr_b16 v[194:195], v220 offset:58368
    ds_read_b64_tr_b16 v[196:197], v221 offset:57344
    ds_read_b64_tr_b16 v[198:199], v221 offset:58368
    s_waitcnt lgkmcnt(9)
    v_mfma_f32_32x32x16_bf16 v[96:111], v[212:215], v[238:241], v[96:111]
    v_mfma_f32_32x32x16_bf16 v[112:127], v[212:215], v[242:245], v[112:127]
    v_mfma_f32_32x32x16_bf16 v[128:143], v[212:215], v[246:249], v[128:143]
    s_waitcnt lgkmcnt(7)
    v_mfma_f32_32x32x16_bf16 v[144:159], v[216:219], v[238:241], v[144:159]
    v_mfma_f32_32x32x16_bf16 v[160:175], v[216:219], v[242:245], v[160:175]
    v_mfma_f32_32x32x16_bf16 v[176:191], v[216:219], v[246:249], v[176:191]
    s_add_u32 s76, s75, 6
    s_and_b32 s76, s76, 7
    s_lshl_b32 s76, s76, 10
    v_add_u32 v234, s76, v226
    ds_read_b128 v[238:241], v234 offset:0
    ds_read_b128 v[242:245], v234 offset:8192
    ds_read_b128 v[246:249], v234 offset:16384
    ds_read_b64_tr_b16 v[212:213], v224 offset:8192
    ds_read_b64_tr_b16 v[214:215], v224 offset:9216
    ds_read_b64_tr_b16 v[216:217], v225 offset:8192
    ds_read_b64_tr_b16 v[218:219], v225 offset:9216
    s_waitcnt lgkmcnt(9)
    v_mfma_f32_32x32x16_bf16 v[96:111], v[192:195], v[200:203], v[96:111]
    v_mfma_f32_32x32x16_bf16 v[112:127], v[192:195], v[204:207], v[112:127]
    v_mfma_f32_32x32x16_bf16 v[128:143], v[192:195], v[208:211], v[128:143]
    s_waitcnt lgkmcnt(7)
    v_mfma_f32_32x32x16_bf16 v[144:159], v[196:199], v[200:203], v[144:159]
    v_mfma_f32_32x32x16_bf16 v[160:175], v[196:199], v[204:207], v[160:175]
    v_mfma_f32_32x32x16_bf16 v[176:191], v[196:199], v[208:211], v[176:191]
    s_add_u32 s76, s75, 7
    s_and_b32 s76, s76, 7
    s_lshl_b32 s76, s76, 10
    v_add_u32 v234, s76, v226
    ds_read_b128 v[200:203], v234 offset:0
    ds_read_b128 v[204:207], v234 offset:8192
    ds_read_b128 v[208:211], v234 offset:16384
    ds_read_b64_tr_b16 v[192:193], v224 offset:16384
    ds_read_b64_tr_b16 v[194:195], v224 offset:17408
    ds_read_b64_tr_b16 v[196:197], v225 offset:16384
    ds_read_b64_tr_b16 v[198:199], v225 offset:17408
    s_waitcnt lgkmcnt(9)
    v_mfma_f32_32x32x16_bf16 v[96:111], v[212:215], v[238:241], v[96:111]
    v_mfma_f32_32x32x16_bf16 v[112:127], v[212:215], v[242:245], v[112:127]
    v_mfma_f32_32x32x16_bf16 v[128:143], v[212:215], v[246:249], v[128:143]
    s_waitcnt lgkmcnt(7)
    v_mfma_f32_32x32x16_bf16 v[144:159], v[216:219], v[238:241], v[144:159]
    v_mfma_f32_32x32x16_bf16 v[160:175], v[216:219], v[242:245], v[160:175]
    v_mfma_f32_32x32x16_bf16 v[176:191], v[216:219], v[246:249], v[176:191]
    s_waitcnt lgkmcnt(2)
    v_mfma_f32_32x32x16_bf16 v[96:111], v[192:195], v[200:203], v[96:111]
    v_mfma_f32_32x32x16_bf16 v[112:127], v[192:195], v[204:207], v[112:127]
    v_mfma_f32_32x32x16_bf16 v[128:143], v[192:195], v[208:211], v[128:143]
    s_waitcnt lgkmcnt(0)
    v_mfma_f32_32x32x16_bf16 v[144:159], v[196:199], v[200:203], v[144:159]
    v_mfma_f32_32x32x16_bf16 v[160:175], v[196:199], v[204:207], v[160:175]
    v_mfma_f32_32x32x16_bf16 v[176:191], v[196:199], v[208:211], v[176:191]
    s_nop 7
    s_nop 3
    v_cvt_pk_bf16_f32 v96, v96, v97
    v_cvt_pk_bf16_f32 v97, v98, v99
    v_cvt_pk_bf16_f32 v98, v100, v101
    v_cvt_pk_bf16_f32 v99, v102, v103
    v_cvt_pk_bf16_f32 v100, v104, v105
    v_cvt_pk_bf16_f32 v101, v106, v107
    v_cvt_pk_bf16_f32 v102, v108, v109
    v_cvt_pk_bf16_f32 v103, v110, v111
    s_mov_b32 s74, 12288
    buffer_store_dwordx4 v[96:99], v236, s[56:59], s74 offen offset:0 sc1
    buffer_store_dwordx4 v[100:103], v236, s[56:59], s74 offen offset:1024 sc1
    v_cvt_pk_bf16_f32 v112, v112, v113
    v_cvt_pk_bf16_f32 v113, v114, v115
    v_cvt_pk_bf16_f32 v114, v116, v117
    v_cvt_pk_bf16_f32 v115, v118, v119
    v_cvt_pk_bf16_f32 v116, v120, v121
    v_cvt_pk_bf16_f32 v117, v122, v123
    v_cvt_pk_bf16_f32 v118, v124, v125
    v_cvt_pk_bf16_f32 v119, v126, v127
    s_mov_b32 s74, 14336
    buffer_store_dwordx4 v[112:115], v236, s[56:59], s74 offen offset:0 sc1
    buffer_store_dwordx4 v[116:119], v236, s[56:59], s74 offen offset:1024 sc1
    v_cvt_pk_bf16_f32 v128, v128, v129
    v_cvt_pk_bf16_f32 v129, v130, v131
    v_cvt_pk_bf16_f32 v130, v132, v133
    v_cvt_pk_bf16_f32 v131, v134, v135
    v_cvt_pk_bf16_f32 v132, v136, v137
    v_cvt_pk_bf16_f32 v133, v138, v139
    v_cvt_pk_bf16_f32 v134, v140, v141
    v_cvt_pk_bf16_f32 v135, v142, v143
    s_mov_b32 s74, 16384
    buffer_store_dwordx4 v[128:131], v236, s[56:59], s74 offen offset:0 sc1
    buffer_store_dwordx4 v[132:135], v236, s[56:59], s74 offen offset:1024 sc1
    v_cvt_pk_bf16_f32 v144, v144, v145
    v_cvt_pk_bf16_f32 v145, v146, v147
    v_cvt_pk_bf16_f32 v146, v148, v149
    v_cvt_pk_bf16_f32 v147, v150, v151
    v_cvt_pk_bf16_f32 v148, v152, v153
    v_cvt_pk_bf16_f32 v149, v154, v155
    v_cvt_pk_bf16_f32 v150, v156, v157
    v_cvt_pk_bf16_f32 v151, v158, v159
    s_mov_b32 s74, 18432
    buffer_store_dwordx4 v[144:147], v236, s[56:59], s74 offen offset:0 sc1
    buffer_store_dwordx4 v[148:151], v236, s[56:59], s74 offen offset:1024 sc1
    v_cvt_pk_bf16_f32 v160, v160, v161
    v_cvt_pk_bf16_f32 v161, v162, v163
    v_cvt_pk_bf16_f32 v162, v164, v165
    v_cvt_pk_bf16_f32 v163, v166, v167
    v_cvt_pk_bf16_f32 v164, v168, v169
    v_cvt_pk_bf16_f32 v165, v170, v171
    v_cvt_pk_bf16_f32 v166, v172, v173
    v_cvt_pk_bf16_f32 v167, v174, v175
    s_mov_b32 s74, 20480
    buffer_store_dwordx4 v[160:163], v236, s[56:59], s74 offen offset:0 sc1
    buffer_store_dwordx4 v[164:167], v236, s[56:59], s74 offen offset:1024 sc1
    v_cvt_pk_bf16_f32 v176, v176, v177
    v_cvt_pk_bf16_f32 v177, v178, v179
    v_cvt_pk_bf16_f32 v178, v180, v181
    v_cvt_pk_bf16_f32 v179, v182, v183
    v_cvt_pk_bf16_f32 v180, v184, v185
    v_cvt_pk_bf16_f32 v181, v186, v187
    v_cvt_pk_bf16_f32 v182, v188, v189
    v_cvt_pk_bf16_f32 v183, v190, v191
    s_mov_b32 s74, 22528
    buffer_store_dwordx4 v[176:179], v236, s[56:59], s74 offen offset:0 sc1
    buffer_store_dwordx4 v[180:183], v236, s[56:59], s74 offen offset:1024 sc1
L_reduce:
    s_mov_b32 s40, s24
    s_and_b32 s41, s25, 0xffff
    s_mov_b32 s42, 3145728
    s_mov_b32 s43, 0x20000
    v_mbcnt_lo_u32_b32 v128, -1, 0
    v_mbcnt_hi_u32_b32 v128, -1, v128
    s_lshr_b32 s78, s34, 3
    s_lshl_b32 s79, s34, 7
    s_add_u32 s79, s79, 83886080
    v_mov_b32 v129, s79
    v_and_b32 v130, 7, v128
    v_lshlrev_b32 v130, 7, v130
    s_lshl_b32 s79, s78, 10
    s_add_u32 s79, s79, 83886080
    v_add_u32 v130, s79, v130
    s_waitcnt vmcnt(0)
    s_barrier
    s_cmp_lg_u32 s30, 0
    s_cbranch_scc1 L_red_go
    s_memrealtime s[80:81]
    s_waitcnt lgkmcnt(0)
    v_mov_b32 v136, s80
    v_mov_b32 v137, s81
    v_cmp_eq_u32 vcc, 0, v128
    s_and_saveexec_b64 s[82:83], vcc
    buffer_store_dwordx2 v[136:137], v129, s[56:59], 0 offen sc1
    s_mov_b64 exec, s[82:83]
    s_mov_b32 s82, 0
    s_add_u32 s98, s98, 2000
    s_addc_u32 s99, s99, 0
    v_mov_b32 v139, s99
L_red_poll:
    buffer_load_dwordx2 v[136:137], v130, s[56:59], 0 offen sc1
    s_waitcnt vmcnt(0)
    v_subrev_co_u32 v136, vcc, s98, v136
    s_nop 1
    v_subb_co_u32 v137, vcc, v137, v139, vcc
    v_lshrrev_b32 v136, 27, v136
    v_or_b32 v136, v136, v137
    v_cmp_ne_u32 vcc, 0, v136
    s_add_u32 s82, s82, 1
    s_cbranch_vccz L_red_go
    s_sleep 8
    s_cmp_lt_u32 s82, 0x40000
    s_cbranch_scc1 L_red_poll
L_red_go:
    s_barrier
    s_cmp_ge_u32 s30, 6
    s_cbranch_scc1 L_red_done
    s_mul_i32 s79, s78, 786432
    s_mul_i32 s80, s32, 12288
    s_add_u32 s79, s79, s80
    s_lshl_b32 s80, s30, 11
    s_add_u32 s79, s79, s80
    s_add_u32 s79, s79, 50331648
    v_lshlrev_b32 v132, 4, v128
    buffer_load_dwordx4 v[32:35], v132, s[56:59], s79 offen offset:0 sc1
    buffer_load_dwordx4 v[36:39], v132, s[56:59], s79 offen offset:1024 sc1
    s_add_u32 s79, s79, 98304
    buffer_load_dwordx4 v[40:43], v132, s[56:59], s79 offen offset:0 sc1
    buffer_load_dwordx4 v[44:47], v132, s[56:59], s79 offen offset:1024 sc1
    s_add_u32 s79, s79, 98304
    buffer_load_dwordx4 v[48:51], v132, s[56:59], s79 offen offset:0 sc1
    buffer_load_dwordx4 v[52:55], v132, s[56:59], s79 offen offset:1024 sc1
    s_add_u32 s79, s79, 98304
    buffer_load_dwordx4 v[56:59], v132, s[56:59], s79 offen offset:0 sc1
    buffer_load_dwordx4 v[60:63], v132, s[56:59], s79 offen offset:1024 sc1
    s_add_u32 s79, s79, 98304
    buffer_load_dwordx4 v[64:67], v132, s[56:59], s79 offen offset:0 sc1
    buffer_load_dwordx4 v[68:71], v132, s[56:59], s79 offen offset:1024 sc1
    s_add_u32 s79, s79, 98304
    buffer_load_dwordx4 v[72:75], v132, s[56:59], s79 offen offset:0 sc1
    buffer_load_dwordx4 v[76:79], v132, s[56:59], s79 offen offset:1024 sc1
    s_add_u32 s79, s79, 98304
    buffer_load_dwordx4 v[80:83], v132, s[56:59], s79 offen offset:0 sc1
    buffer_load_dwordx4 v[84:87], v132, s[56:59], s79 offen offset:1024 sc1
    s_add_u32 s79, s79, 98304
    buffer_load_dwordx4 v[88:91], v132, s[56:59], s79 offen offset:0 sc1
    buffer_load_dwordx4 v[92:95], v132, s[56:59], s79 offen offset:1024 sc1
    s_cmp_ge_u32 s30, 3
    s_cselect_b32 s80, 1, 0
    s_mul_i32 s81, s80, 3
    s_sub_u32 s81, s30, s81
    s_lshl_b32 s82, s32, 1
    s_add_u32 s82, s82, s80
    s_lshl_b32 s82, s82, 6
    s_mul_i32 s83, s33, 96
    s_lshl_b32 s81, s81, 5
    s_add_u32 s83, s83, s81
    s_lshl_b32 s83, s83, 11
    s_add_u32 s83, s83, s82
    s_lshl_b32 s81, s31, 10
    s_add_u32 s83, s83, s81
    v_and_b32 v133, 31, v128
    v_lshlrev_b32 v133, 11, v133
    v_lshrrev_b32 v134, 5, v128
    v_lshl_add_u32 v133, v134, 4, v133
    s_waitcnt vmcnt(14)
    v_lshlrev_b32 v144, 16, v32
    v_and_b32 v145, 0xffff0000, v32
    v_lshlrev_b32 v146, 16, v33
    v_and_b32 v147, 0xffff0000, v33
    v_lshlrev_b32 v148, 16, v34
    v_and_b32 v149, 0xffff0000, v34
    v_lshlrev_b32 v150, 16, v35
    v_and_b32 v151, 0xffff0000, v35
    v_lshlrev_b32 v152, 16, v36
    v_and_b32 v153, 0xffff0000, v36
    v_lshlrev_b32 v154, 16, v37
    v_and_b32 v155, 0xffff0000, v37
    v_lshlrev_b32 v156, 16, v38
    v_and_b32 v157, 0xffff0000, v38
    v_lshlrev_b32 v158, 16, v39
    v_and_b32 v159, 0xffff0000, v39
    s_waitcnt vmcnt(12)
    v_lshlrev_b32 v160, 16, v40
    v_and_b32 v161, 0xffff0000, v40
    v_lshlrev_b32 v162, 16, v41
    v_and_b32 v163, 0xffff0000, v41
    v_lshlrev_b32 v164, 16, v42
    v_and_b32 v165, 0xffff0000, v42
    v_lshlrev_b32 v166, 16, v43
    v_and_b32 v167, 0xffff0000, v43
    v_lshlrev_b32 v168, 16, v44
    v_and_b32 v169, 0xffff0000, v44
    v_lshlrev_b32 v170, 16, v45
    v_and_b32 v171, 0xffff0000, v45
    v_lshlrev_b32 v172, 16, v46
    v_and_b32 v173, 0xffff0000, v46
    v_lshlrev_b32 v174, 16, v47
    v_and_b32 v175, 0xffff0000, v47
    v_add_f32 v144, v144, v160
    v_add_f32 v145, v145, v161
    v_add_f32 v146, v146, v162
    v_add_f32 v147, v147, v163
    v_add_f32 v148, v148, v164
    v_add_f32 v149, v149, v165
    v_add_f32 v150, v150, v166
    v_add_f32 v151, v151, v167
    v_add_f32 v152, v152, v168
    v_add_f32 v153, v153, v169
    v_add_f32 v154, v154, v170
    v_add_f32 v155, v155, v171
    v_add_f32 v156, v156, v172
    v_add_f32 v157, v157, v173
    v_add_f32 v158, v158, v174
    v_add_f32 v159, v159, v175
    s_waitcnt vmcnt(10)
    v_lshlrev_b32 v160, 16, v48
    v_and_b32 v161, 0xffff0000, v48
    v_lshlrev_b32 v162, 16, v49
    v_and_b32 v163, 0xffff0000, v49
    v_lshlrev_b32 v164, 16, v50
    v_and_b32 v165, 0xffff0000, v50
    v_lshlrev_b32 v166, 16, v51
    v_and_b32 v167, 0xffff0000, v51
    v_lshlrev_b32 v168, 16, v52
    v_and_b32 v169, 0xffff0000, v52
    v_lshlrev_b32 v170, 16, v53
    v_and_b32 v171, 0xffff0000, v53
    v_lshlrev_b32 v172, 16, v54
    v_and_b32 v173, 0xffff0000, v54
    v_lshlrev_b32 v174, 16, v55
    v_and_b32 v175, 0xffff0000, v55
    v_add_f32 v144, v144, v160
    v_add_f32 v145, v145, v161
    v_add_f32 v146, v146, v162
    v_add_f32 v147, v147, v163
    v_add_f32 v148, v148, v164
    v_add_f32 v149, v149, v165
    v_add_f32 v150, v150, v166
    v_add_f32 v151, v151, v167
    v_add_f32 v152, v152, v168
    v_add_f32 v153, v153, v169
    v_add_f32 v154, v154, v170
    v_add_f32 v155, v155, v171
    v_add_f32 v156, v156, v172
    v_add_f32 v157, v157, v173
    v_add_f32 v158, v158, v174
    v_add_f32 v159, v159, v175
    s_waitcnt vmcnt(8)
    v_lshlrev_b32 v160, 16, v56
    v_and_b32 v161, 0xffff0000, v56
    v_lshlrev_b32 v162, 16, v57
    v_and_b32 v163, 0xffff0000, v57
    v_lshlrev_b32 v164, 16, v58
    v_and_b32 v165, 0xffff0000, v58
    v_lshlrev_b32 v166, 16, v59
    v_and_b32 v167, 0xffff0000, v59
    v_lshlrev_b32 v168, 16, v60
    v_and_b32 v169, 0xffff0000, v60
    v_lshlrev_b32 v170, 16, v61
    v_and_b32 v171, 0xffff0000, v61
    v_lshlrev_b32 v172, 16, v62
    v_and_b32 v173, 0xffff0000, v62
    v_lshlrev_b32 v174, 16, v63
    v_and_b32 v175, 0xffff0000, v63
    v_add_f32 v144, v144, v160
    v_add_f32 v145, v145, v161
    v_add_f32 v146, v146, v162
    v_add_f32 v147, v147, v163
    v_add_f32 v148, v148, v164
    v_add_f32 v149, v149, v165
    v_add_f32 v150, v150, v166
    v_add_f32 v151, v151, v167
    v_add_f32 v152, v152, v168
    v_add_f32 v153, v153, v169
    v_add_f32 v154, v154, v170
    v_add_f32 v155, v155, v171
    v_add_f32 v156, v156, v172
    v_add_f32 v157, v157, v173
    v_add_f32 v158, v158, v174
    v_add_f32 v159, v159, v175
    s_waitcnt vmcnt(6)
    v_lshlrev_b32 v160, 16, v64
    v_and_b32 v161, 0xffff0000, v64
    v_lshlrev_b32 v162, 16, v65
    v_and_b32 v163, 0xffff0000, v65
    v_lshlrev_b32 v164, 16, v66
    v_and_b32 v165, 0xffff0000, v66
    v_lshlrev_b32 v166, 16, v67
    v_and_b32 v167, 0xffff0000, v67
    v_lshlrev_b32 v168, 16, v68
    v_and_b32 v169, 0xffff0000, v68
    v_lshlrev_b32 v170, 16, v69
    v_and_b32 v171, 0xffff0000, v69
    v_lshlrev_b32 v172, 16, v70
    v_and_b32 v173, 0xffff0000, v70
    v_lshlrev_b32 v174, 16, v71
    v_and_b32 v175, 0xffff0000, v71
    v_add_f32 v144, v144, v160
    v_add_f32 v145, v145, v161
    v_add_f32 v146, v146, v162
    v_add_f32 v147, v147, v163
    v_add_f32 v148, v148, v164
    v_add_f32 v149, v149, v165
    v_add_f32 v150, v150, v166
    v_add_f32 v151, v151, v167
    v_add_f32 v152, v152, v168
    v_add_f32 v153, v153, v169
    v_add_f32 v154, v154, v170
    v_add_f32 v155, v155, v171
    v_add_f32 v156, v156, v172
    v_add_f32 v157, v157, v173
    v_add_f32 v158, v158, v174
    v_add_f32 v159, v159, v175
    s_waitcnt vmcnt(4)
    v_lshlrev_b32 v160, 16, v72
    v_and_b32 v161, 0xffff0000, v72
    v_lshlrev_b32 v162, 16, v73
    v_and_b32 v163, 0xffff0000, v73
    v_lshlrev_b32 v164, 16, v74
    v_and_b32 v165, 0xffff0000, v74
    v_lshlrev_b32 v166, 16, v75
    v_and_b32 v167, 0xffff0000, v75
    v_lshlrev_b32 v168, 16, v76
    v_and_b32 v169, 0xffff0000, v76
    v_lshlrev_b32 v170, 16, v77
    v_and_b32 v171, 0xffff0000, v77
    v_lshlrev_b32 v172, 16, v78
    v_and_b32 v173, 0xffff0000, v78
    v_lshlrev_b32 v174, 16, v79
    v_and_b32 v175, 0xffff0000, v79
    v_add_f32 v144, v144, v160
    v_add_f32 v145, v145, v161
    v_add_f32 v146, v146, v162
    v_add_f32 v147, v147, v163
    v_add_f32 v148, v148, v164
    v_add_f32 v149, v149, v165
    v_add_f32 v150, v150, v166
    v_add_f32 v151, v151, v167
    v_add_f32 v152, v152, v168
    v_add_f32 v153, v153, v169
    v_add_f32 v154, v154, v170
    v_add_f32 v155, v155, v171
    v_add_f32 v156, v156, v172
    v_add_f32 v157, v157, v173
    v_add_f32 v158, v158, v174
    v_add_f32 v159, v159, v175
    s_waitcnt vmcnt(2)
    v_lshlrev_b32 v160, 16, v80
    v_and_b32 v161, 0xffff0000, v80
    v_lshlrev_b32 v162, 16, v81
    v_and_b32 v163, 0xffff0000, v81
    v_lshlrev_b32 v164, 16, v82
    v_and_b32 v165, 0xffff0000, v82
    v_lshlrev_b32 v166, 16, v83
    v_and_b32 v167, 0xffff0000, v83
    v_lshlrev_b32 v168, 16, v84
    v_and_b32 v169, 0xffff0000, v84
    v_lshlrev_b32 v170, 16, v85
    v_and_b32 v171, 0xffff0000, v85
    v_lshlrev_b32 v172, 16, v86
    v_and_b32 v173, 0xffff0000, v86
    v_lshlrev_b32 v174, 16, v87
    v_and_b32 v175, 0xffff0000, v87
    v_add_f32 v144, v144, v160
    v_add_f32 v145, v145, v161
    v_add_f32 v146, v146, v162
    v_add_f32 v147, v147, v163
    v_add_f32 v148, v148, v164
    v_add_f32 v149, v149, v165
    v_add_f32 v150, v150, v166
    v_add_f32 v151, v151, v167
    v_add_f32 v152, v152, v168
    v_add_f32 v153, v153, v169
    v_add_f32 v154, v154, v170
    v_add_f32 v155, v155, v171
    v_add_f32 v156, v156, v172
    v_add_f32 v157, v157, v173
    v_add_f32 v158, v158, v174
    v_add_f32 v159, v159, v175
    s_waitcnt vmcnt(0)
    v_lshlrev_b32 v160, 16, v88
    v_and_b32 v161, 0xffff0000, v88
    v_lshlrev_b32 v162, 16, v89
    v_and_b32 v163, 0xffff0000, v89
    v_lshlrev_b32 v164, 16, v90
    v_and_b32 v165, 0xffff0000, v90
    v_lshlrev_b32 v166, 16, v91
    v_and_b32 v167, 0xffff0000, v91
    v_lshlrev_b32 v168, 16, v92
    v_and_b32 v169, 0xffff0000, v92
    v_lshlrev_b32 v170, 16, v93
    v_and_b32 v171, 0xffff0000, v93
    v_lshlrev_b32 v172, 16, v94
    v_and_b32 v173, 0xffff0000, v94
    v_lshlrev_b32 v174, 16, v95
    v_and_b32 v175, 0xffff0000, v95
    v_add_f32 v144, v144, v160
    v_add_f32 v145, v145, v161
    v_add_f32 v146, v146, v162
    v_add_f32 v147, v147, v163
    v_add_f32 v148, v148, v164
    v_add_f32 v149, v149, v165
    v_add_f32 v150, v150, v166
    v_add_f32 v151, v151, v167
    v_add_f32 v152, v152, v168
    v_add_f32 v153, v153, v169
    v_add_f32 v154, v154, v170
    v_add_f32 v155, v155, v171
    v_add_f32 v156, v156, v172
    v_add_f32 v157, v157, v173
    v_add_f32 v158, v158, v174
    v_add_f32 v159, v159, v175
    v_cvt_pk_bf16_f32 v160, v144, v145
    v_cvt_pk_bf16_f32 v161, v146, v147
    v_cvt_pk_bf16_f32 v162, v148, v149
    v_cvt_pk_bf16_f32 v163, v150, v151
    buffer_store_dwordx4 v[160:163], v133, s[40:43], s83 offen offset:0
    v_cvt_pk_bf16_f32 v164, v152, v153
    v_cvt_pk_bf16_f32 v165, v154, v155
    v_cvt_pk_bf16_f32 v166, v156, v157
    v_cvt_pk_bf16_f32 v167, v158, v159
    buffer_store_dwordx4 v[164:167], v133, s[40:43], s83 offen offset:32
L_red_done:
    s_waitcnt vmcnt(0)
L_end:
    s_endpgm
.section .rodata,"a"
.p2align 6
.amdhsa_kernel concat_heads__mha_block_cached__gqa_block_cached__near_ridge_kernel
  .amdhsa_next_free_vgpr 256
  .amdhsa_next_free_sgpr 102
  .amdhsa_accum_offset 256
  .amdhsa_group_segment_fixed_size 0
  .amdhsa_kernarg_size 104
  .amdhsa_user_sgpr_count 2
  .amdhsa_user_sgpr_kernarg_segment_ptr 1
  .amdhsa_system_sgpr_workgroup_id_x 1
.end_amdhsa_kernel
```
